```python
import torch

def _softmax(x, axis=-1):
    return torch.softmax(x, dim=axis)

def _gelu(x):
    return torch.nn.functional.gelu(x, approximate='tanh')

def _silu(x):
    return torch.nn.functional.silu(x)

def _sigmoid(x):
    return torch.sigmoid(x)

def _layernorm(x, axis=-1, eps=1e-05):
    m = x.mean(dim=axis, keepdim=True)
    v = x.var(dim=axis, keepdim=True, unbiased=False)
    return (x - m) / torch.sqrt(v + eps)

def _scatter_add(tgt, idx, src, axis=0):
    return tgt.clone().index_add_(axis, idx, src)

def _segment_sum(src, seg, n):
    out = torch.zeros((n,) + src.shape[1:], dtype=src.dtype)
    return out.index_add_(0, seg, src)

def _pad(x, pw):
    flat = tuple((v for pair in reversed(pw) for v in pair))
    return torch.nn.functional.pad(x, flat)
kernel_name = 'adaLN_cond__sliding_block_cached__glu_gated_bilinear__decode'

def setup_inputs():

    _w = lambda a: (lambda t: t.to(torch.bfloat16) if t.is_floating_point() else t)(torch.as_tensor(a))

    def _A_setup():
        B, Sq, D = (1, 1, 640)
        Hq, Hkv, Sk, Dh = (32, 32, 32768, 192)
        assert Hq % Hkv == 0, (Hq, Hkv)
        return {'x': _w((lambda *s: torch.randn(*s, dtype=torch.bfloat16) * 0.05)(B, Sq, D)), 'k_cache': _w((lambda *s: torch.randn(*s, dtype=torch.bfloat16) * 3.2)(B, Hkv, Sk, Dh)), 'v_cache': _w((lambda *s: torch.randn(*s, dtype=torch.bfloat16) * 3.2)(B, Hkv, Sk, Dh)), 'wq': _w((lambda *s: torch.randn(*s, dtype=torch.bfloat16) * 3.2)(D, Hq * Dh) * D ** (-0.5)), 'wo': _w((lambda *s: torch.randn(*s, dtype=torch.bfloat16) * 3.2)(Hq * Dh, D) * (Hq * Dh) ** (-0.5))}
    _A_in = _A_setup()

    def _B_setup():
        B, S, D, F = (1, 1, 640, 1536)
        return {'x': _w((lambda *s: torch.randn(*s, dtype=torch.bfloat16) * 0.05)(B, S, D)), 'w_gate': _w((lambda *s: torch.randn(*s, dtype=torch.bfloat16) * 3.2)(D, F) * D ** (-0.5)), 'w_up': _w((lambda *s: torch.randn(*s, dtype=torch.bfloat16) * 3.2)(D, F) * D ** (-0.5)), 'w_down': _w((lambda *s: torch.randn(*s, dtype=torch.bfloat16) * 3.2)(F, D) * F ** (-0.5))}
    _B_in = _B_setup()
    return {'A_x': _A_in['x'], 'A_k_cache': _A_in['k_cache'], 'A_v_cache': _A_in['v_cache'], 'A_wq': _A_in['wq'], 'A_wo': _A_in['wo'], 'B_x': _B_in['x'], 'B_w_gate': _B_in['w_gate'], 'B_w_up': _B_in['w_up'], 'B_w_down': _B_in['w_down'], 'c': _w((lambda *s: torch.randn(*s, dtype=torch.bfloat16) * 0.2)(1, 640) * 8.0), 'w_mod': _w((lambda *s: torch.randn(*s, dtype=torch.bfloat16) * 0.2)(640, 6 * 640) * 640 ** (-0.5) * 8.0)}

def reference(A_x, A_k_cache, A_v_cache, A_wq, A_wo, B_x, B_w_gate, B_w_up, B_w_down, c, w_mod):

    def _A_ref(x, k_cache, v_cache, wq, wo):
        B, Sq, D = x.shape
        Hq, Dh = (32, 192)
        Hkv, Sk = (k_cache.shape[1], k_cache.shape[2])
        W = min(4096, max(256, Sk // 4))
        rep = Hq // Hkv
        q = (lambda x, *d: x.permute(*d))((x @ wq).reshape(B, Sq, Hq, Dh), 0, 2, 1, 3)
        k = (lambda x, n, axis: torch.repeat_interleave(x, n, dim=axis))(k_cache[:, :, Sk - W:, :], rep, axis=1)
        v = (lambda x, n, axis: torch.repeat_interleave(x, n, dim=axis))(v_cache[:, :, Sk - W:, :], rep, axis=1)
        scores = torch.einsum('bhqd,bhkd->bhqk', q, k) * Dh ** (-0.5)
        p = _softmax(scores, axis=-1)
        o = torch.einsum('bhqk,bhkd->bhqd', p, v)
        return (lambda x, *d: x.permute(*d))(o, 0, 2, 1, 3).reshape(B, Sq, Hq * Dh) @ wo

    def _B_ref(x, w_gate, w_up, w_down):
        g = torch.einsum('bsd,df->bsf', x, w_gate)
        u = torch.einsum('bsd,df->bsf', x, w_up)
        h = g * u
        return torch.einsum('bsf,fd->bsd', h, w_down)
    x = A_x
    mod = (_silu(c) @ w_mod).reshape(c.shape[0], 6, 1, -1)
    sa, ca, ga, sb, cb, gb = (mod[:, 0].clone(), mod[:, 1].clone(), mod[:, 2].clone(), mod[:, 3].clone(), mod[:, 4].clone(), mod[:, 5].clone())
    h = _layernorm(x, axis=-1) * (1 + ca) + sa
    x = x + ga * _A_ref(h, A_k_cache, A_v_cache, A_wq, A_wo)
    h = _layernorm(x, axis=-1) * (1 + cb) + sb
    x = x + gb * _B_ref(h, B_w_gate, B_w_up, B_w_down)
    return x
```

```asm
; @launch grid=(256,1,1) block=(768,1,1) lds=163840
.amdgcn_target "amdgcn-amd-amdhsa--gfx950"
.text
.globl adaLN_cond__sliding_block_cached__glu_gated_bilinear__decode_kernel
.p2align 8
.type adaLN_cond__sliding_block_cached__glu_gated_bilinear__decode_kernel,@function
adaLN_cond__sliding_block_cached__glu_gated_bilinear__decode_kernel:
s_cmp_ge_u32 s2, 256
s_cbranch_scc1 L_end
s_load_dwordx16 s[16:31], s[0:1], 0
s_load_dwordx8 s[32:39], s[0:1], 64
s_load_dwordx4 s[40:43], s[0:1], 96
v_lshrrev_b32 v2, 6, v0
v_and_b32 v1, 63, v0
v_readfirstlane_b32 s3, v2
s_and_b32 s4, s2, 7
s_lshr_b32 s5, s2, 3
s_lshl_b32 s6, s4, 5
s_add_u32 s6, s6, s5
v_mov_b32 v3, 0
v_lshlrev_b32 v4, 2, v1
s_cmp_lg_u32 s3, 0
s_cbranch_scc1 L_noinit
ds_write_b32 v4, v3
L_noinit:
s_mul_hi_u32 s8, s2, 0x4444445
s_mul_i32 s9, s8, 60
s_sub_u32 s9, s2, s9
s_waitcnt lgkmcnt(0)
s_load_dword s0, s[42:43], 901120
s_mul_i32 s84, s5, 12582912
s_mul_i32 s85, s4, 196608
s_add_u32 s84, s84, s85
s_add_u32 s84, s84, 11010048
s_add_u32 s44, s18, s84
s_addc_u32 s45, s19, 0
s_and_b32 s45, s45, 0xffff
s_mov_b32 s46, 196608
s_mov_b32 s47, 0x20000
s_add_u32 s48, s20, s84
s_addc_u32 s49, s21, 0
s_and_b32 s49, s49, 0xffff
s_mov_b32 s50, 196608
s_mov_b32 s51, 0x20000
s_mov_b32 s52, s42
s_and_b32 s53, s43, 0xffff
s_mov_b32 s54, 2097152
s_mov_b32 s55, 0x20000
s_mov_b32 s60, s22
s_and_b32 s61, s23, 0xffff
s_mov_b32 s62, 7864320
s_mov_b32 s63, 0x20000
s_mov_b32 s64, s36
s_and_b32 s65, s37, 0xffff
s_mov_b32 s66, 4915200
s_mov_b32 s67, 0x20000
s_mov_b32 s68, s16
s_and_b32 s69, s17, 0xffff
s_mov_b32 s70, 1280
s_mov_b32 s71, 0x20000
s_mov_b32 s72, s34
s_and_b32 s73, s35, 0xffff
s_mov_b32 s74, 1280
s_mov_b32 s75, 0x20000
s_mov_b32 s76, s40
s_and_b32 s77, s41, 0xffff
s_mov_b32 s78, 256
s_mov_b32 s79, 0x20000
s_mov_b32 s80, s38
s_and_b32 s81, s39, 0xffff
s_mov_b32 s82, 1280
s_mov_b32 s83, 0x20000
s_cmp_lt_u32 s6, 120
s_cbranch_scc1 L_roleW
s_cmp_lt_u32 s6, 216
s_cbranch_scc1 L_roleG
s_cmp_lt_u32 s6, 236
s_cbranch_scc1 L_roleD
s_mov_b32 s7, 3
s_mov_b32 s10, 0
s_mov_b32 s11, 0
s_mov_b32 s12, 0
s_mov_b32 s13, 0
s_mov_b32 s14, 0
s_mov_b32 s15, 0x40000000
s_mov_b32 s86, 3
s_mov_b32 s87, 0
s_mov_b32 s56, s24
s_and_b32 s57, s25, 0xffff
s_mov_b32 s58, 0
s_mov_b32 s59, 0x20000
s_branch L_roledone
L_roleW:
s_mov_b32 s7, 0
s_mul_hi_u32 s10, s6, 0x1999999a
s_mul_i32 s11, s10, 10
s_sub_u32 s11, s6, s11
s_mul_i32 s84, s10, 655360
s_lshl_b32 s85, s11, 7
s_add_u32 s84, s84, s85
s_sub_u32 s85, 7864320, s84
s_add_u32 s56, s24, s84
s_addc_u32 s57, s25, 0
s_and_b32 s57, s57, 0xffff
s_mov_b32 s58, s85
s_mov_b32 s59, 0x20000
s_mov_b32 s12, 0
s_mov_b32 s13, 8
s_mov_b32 s14, 10240
s_mul_i32 s15, s10, 2560
s_lshl_b32 s85, s11, 8
s_add_u32 s15, s15, s85
s_add_u32 s15, s15, 0
s_mov_b32 s86, 3
s_mov_b32 s87, 1280
s_branch L_roledone
L_roleG:
s_mov_b32 s7, 1
s_sub_u32 s84, s6, 120
s_cmp_ge_u32 s84, 48
s_cselect_b32 s10, 1, 0
s_mul_i32 s85, s10, 48
s_sub_u32 s84, s84, s85
s_lshr_b32 s11, s84, 1
s_and_b32 s12, s84, 1
s_mul_i32 s84, s12, 983040
s_lshl_b32 s85, s11, 7
s_add_u32 s84, s84, s85
s_sub_u32 s85, 1966080, s84
s_cmp_eq_u32 s10, 0
s_cselect_b32 s88, s28, s30
s_cselect_b32 s89, s29, s31
s_add_u32 s56, s88, s84
s_addc_u32 s57, s89, 0
s_and_b32 s57, s57, 0xffff
s_mov_b32 s58, s85
s_mov_b32 s59, 0x20000
s_mov_b32 s13, 5
s_mov_b32 s14, 24576
s_lshl_b32 s15, s12, 1
s_add_u32 s15, s15, s10
s_mul_i32 s15, s15, 6144
s_lshl_b32 s85, s11, 8
s_add_u32 s15, s15, s85
s_add_u32 s15, s15, 30720
s_mov_b32 s86, 3
s_mov_b32 s87, 3072
s_branch L_roledone
L_roleD:
s_mov_b32 s7, 2
s_sub_u32 s10, s6, 216
s_mov_b32 s11, 0
s_mov_b32 s12, 0
s_lshl_b32 s84, s10, 6
s_sub_u32 s85, 1966080, s84
s_add_u32 s56, s32, s84
s_addc_u32 s57, s33, 0
s_and_b32 s57, s57, 0xffff
s_mov_b32 s58, s85
s_mov_b32 s59, 0x20000
s_mov_b32 s13, 12
s_mov_b32 s14, 20480
s_mov_b32 s15, 0x40000000
s_mov_b32 s86, 2
s_mov_b32 s87, 1280
L_roledone:
s_waitcnt lgkmcnt(0)
s_mul_i32 s42, s0, 1664525
s_add_u32 s42, s42, 1013904223
s_barrier
s_cmp_ge_u32 s3, 8
s_cbranch_scc1 L_helper
v_lshrrev_b32 v2, 3, v1
v_and_b32 v3, 7, v1
v_mul_u32_u24 v2, 384, v2
v_lshlrev_b32 v4, 4, v3
v_add_u32 v2, v2, v4
s_mul_i32 s84, s3, 3072
v_add_u32 v2, s84, v2
v_mov_b32 v6, 0
L_kgate:
ds_read_b32 v7, v6 offset:0
s_waitcnt lgkmcnt(0)
v_readfirstlane_b32 s84, v7
s_nop 1
s_cmp_ge_u32 s84, 4
s_cbranch_scc1 L_kgate_d
s_sleep 1
s_branch L_kgate
L_kgate_d:
s_mul_i32 s86, s3, 3072
s_add_u32 s86, s86, 65536
s_mov_b32 s84, 0
buffer_load_dwordx4 v[8:11], v2, s[44:47], s84 offen offset:0 nt
buffer_load_dwordx4 v[12:15], v2, s[44:47], s84 offen offset:128 nt
buffer_load_dwordx4 v[16:19], v2, s[44:47], s84 offen offset:256 nt
s_mov_b32 s84, 24576
buffer_load_dwordx4 v[20:23], v2, s[44:47], s84 offen offset:0 nt
buffer_load_dwordx4 v[24:27], v2, s[44:47], s84 offen offset:128 nt
buffer_load_dwordx4 v[28:31], v2, s[44:47], s84 offen offset:256 nt
s_waitcnt vmcnt(3)
s_mov_b32 s84, 49152
buffer_load_dwordx4 v[32:35], v2, s[44:47], s84 offen offset:0 nt
buffer_load_dwordx4 v[36:39], v2, s[44:47], s84 offen offset:128 nt
buffer_load_dwordx4 v[40:43], v2, s[44:47], s84 offen offset:256 nt
s_waitcnt vmcnt(3)
s_mov_b32 s84, 73728
buffer_load_dwordx4 v[44:47], v2, s[44:47], s84 offen offset:0 nt
buffer_load_dwordx4 v[48:51], v2, s[44:47], s84 offen offset:128 nt
buffer_load_dwordx4 v[52:55], v2, s[44:47], s84 offen offset:256 nt
s_waitcnt vmcnt(3)
s_mov_b32 s84, 98304
buffer_load_dwordx4 v[56:59], v2, s[44:47], s84 offen offset:0 nt
buffer_load_dwordx4 v[60:63], v2, s[44:47], s84 offen offset:128 nt
buffer_load_dwordx4 v[64:67], v2, s[44:47], s84 offen offset:256 nt
s_waitcnt vmcnt(3)
s_mov_b32 s84, 122880
buffer_load_dwordx4 v[68:71], v2, s[44:47], s84 offen offset:0 nt
buffer_load_dwordx4 v[72:75], v2, s[44:47], s84 offen offset:128 nt
buffer_load_dwordx4 v[76:79], v2, s[44:47], s84 offen offset:256 nt
s_waitcnt vmcnt(3)
s_mov_b32 s84, 147456
buffer_load_dwordx4 v[80:83], v2, s[44:47], s84 offen offset:0 nt
buffer_load_dwordx4 v[84:87], v2, s[44:47], s84 offen offset:128 nt
buffer_load_dwordx4 v[88:91], v2, s[44:47], s84 offen offset:256 nt
s_waitcnt vmcnt(3)
s_mov_b32 s84, 172032
buffer_load_dwordx4 v[92:95], v2, s[44:47], s84 offen offset:0 nt
buffer_load_dwordx4 v[96:99], v2, s[44:47], s84 offen offset:128 nt
buffer_load_dwordx4 v[100:103], v2, s[44:47], s84 offen offset:256 nt
s_waitcnt vmcnt(3)
s_mov_b32 s84, 0
s_add_u32 m0, s86, 0
s_nop 0
buffer_load_dwordx4 v2, s[48:51], s84 offen offset:0 nt lds
s_add_u32 m0, s86, 896
s_nop 0
buffer_load_dwordx4 v2, s[48:51], s84 offen offset:128 nt lds
s_add_u32 m0, s86, 1792
s_nop 0
buffer_load_dwordx4 v2, s[48:51], s84 offen offset:256 nt lds
s_waitcnt vmcnt(3)
s_mov_b32 s84, 24576
s_add_u32 m0, s86, 24576
s_nop 0
buffer_load_dwordx4 v2, s[48:51], s84 offen offset:0 nt lds
s_add_u32 m0, s86, 25472
s_nop 0
buffer_load_dwordx4 v2, s[48:51], s84 offen offset:128 nt lds
s_add_u32 m0, s86, 26368
s_nop 0
buffer_load_dwordx4 v2, s[48:51], s84 offen offset:256 nt lds
v_mov_b32 v104, 0
v_mov_b32 v105, 0
v_mov_b32 v106, 0
v_mov_b32 v107, 0
v_mov_b32 v108, 0
v_mov_b32 v109, 0
v_mov_b32 v110, 0
v_mov_b32 v111, 0
v_mov_b32 v112, 0
v_mov_b32 v113, 0
v_mov_b32 v114, 0
v_mov_b32 v115, 0
v_mov_b32 v116, 0
v_mov_b32 v117, 0
v_mov_b32 v118, 0
v_mov_b32 v119, 0
v_mov_b32 v120, 0
v_mov_b32 v121, 0
v_mov_b32 v122, 0
v_mov_b32 v123, 0
v_mov_b32 v124, 0
v_mov_b32 v125, 0
v_mov_b32 v126, 0
v_mov_b32 v127, 0
v_lshlrev_b32 v4, 4, v3
v_mov_b32 v6, 0
L_qwait:
ds_read_b32 v7, v6 offset:8
s_waitcnt lgkmcnt(0)
v_readfirstlane_b32 s84, v7
s_nop 1
s_cmp_ge_u32 s84, 3
s_cbranch_scc1 L_qwait_d
s_sleep 1
s_branch L_qwait
L_qwait_d:
ds_read_b128 v[128:131], v4 offset:256
ds_read_b128 v[132:135], v4 offset:384
ds_read_b128 v[136:139], v4 offset:512
s_waitcnt lgkmcnt(0)
v_dot2_f32_bf16 v148, v8, v128, 0
v_dot2_f32_bf16 v149, v12, v132, 0
v_dot2_f32_bf16 v150, v16, v136, 0
s_nop 0
v_dot2c_f32_bf16 v148, v9, v129
v_dot2c_f32_bf16 v149, v13, v133
v_dot2c_f32_bf16 v150, v17, v137
v_dot2c_f32_bf16 v148, v10, v130
v_dot2c_f32_bf16 v149, v14, v134
v_dot2c_f32_bf16 v150, v18, v138
v_dot2c_f32_bf16 v148, v11, v131
v_dot2c_f32_bf16 v149, v15, v135
v_dot2c_f32_bf16 v150, v19, v139
s_nop 1
v_add_f32 v148, v148, v149
v_add_f32 v140, v148, v150
v_dot2_f32_bf16 v148, v20, v128, 0
v_dot2_f32_bf16 v149, v24, v132, 0
v_dot2_f32_bf16 v150, v28, v136, 0
s_nop 0
v_dot2c_f32_bf16 v148, v21, v129
v_dot2c_f32_bf16 v149, v25, v133
v_dot2c_f32_bf16 v150, v29, v137
v_dot2c_f32_bf16 v148, v22, v130
v_dot2c_f32_bf16 v149, v26, v134
v_dot2c_f32_bf16 v150, v30, v138
v_dot2c_f32_bf16 v148, v23, v131
v_dot2c_f32_bf16 v149, v27, v135
v_dot2c_f32_bf16 v150, v31, v139
s_nop 1
v_add_f32 v148, v148, v149
v_add_f32 v141, v148, v150
s_waitcnt vmcnt(3)
s_mov_b32 s84, 49152
buffer_load_dwordx4 v[8:11], v2, s[48:51], s84 offen offset:0 nt
buffer_load_dwordx4 v[12:15], v2, s[48:51], s84 offen offset:128 nt
buffer_load_dwordx4 v[16:19], v2, s[48:51], s84 offen offset:256 nt
v_dot2_f32_bf16 v148, v32, v128, 0
v_dot2_f32_bf16 v149, v36, v132, 0
v_dot2_f32_bf16 v150, v40, v136, 0
s_nop 0
v_dot2c_f32_bf16 v148, v33, v129
v_dot2c_f32_bf16 v149, v37, v133
v_dot2c_f32_bf16 v150, v41, v137
v_dot2c_f32_bf16 v148, v34, v130
v_dot2c_f32_bf16 v149, v38, v134
v_dot2c_f32_bf16 v150, v42, v138
v_dot2c_f32_bf16 v148, v35, v131
v_dot2c_f32_bf16 v149, v39, v135
v_dot2c_f32_bf16 v150, v43, v139
s_nop 1
v_add_f32 v148, v148, v149
v_add_f32 v142, v148, v150
v_dot2_f32_bf16 v148, v44, v128, 0
v_dot2_f32_bf16 v149, v48, v132, 0
v_dot2_f32_bf16 v150, v52, v136, 0
s_nop 0
v_dot2c_f32_bf16 v148, v45, v129
v_dot2c_f32_bf16 v149, v49, v133
v_dot2c_f32_bf16 v150, v53, v137
v_dot2c_f32_bf16 v148, v46, v130
v_dot2c_f32_bf16 v149, v50, v134
v_dot2c_f32_bf16 v150, v54, v138
v_dot2c_f32_bf16 v148, v47, v131
v_dot2c_f32_bf16 v149, v51, v135
v_dot2c_f32_bf16 v150, v55, v139
s_nop 1
v_add_f32 v148, v148, v149
v_add_f32 v143, v148, v150
s_waitcnt vmcnt(3)
s_mov_b32 s84, 73728
buffer_load_dwordx4 v[20:23], v2, s[48:51], s84 offen offset:0 nt
buffer_load_dwordx4 v[24:27], v2, s[48:51], s84 offen offset:128 nt
buffer_load_dwordx4 v[28:31], v2, s[48:51], s84 offen offset:256 nt
v_dot2_f32_bf16 v148, v56, v128, 0
v_dot2_f32_bf16 v149, v60, v132, 0
v_dot2_f32_bf16 v150, v64, v136, 0
s_nop 0
v_dot2c_f32_bf16 v148, v57, v129
v_dot2c_f32_bf16 v149, v61, v133
v_dot2c_f32_bf16 v150, v65, v137
v_dot2c_f32_bf16 v148, v58, v130
v_dot2c_f32_bf16 v149, v62, v134
v_dot2c_f32_bf16 v150, v66, v138
v_dot2c_f32_bf16 v148, v59, v131
v_dot2c_f32_bf16 v149, v63, v135
v_dot2c_f32_bf16 v150, v67, v139
s_nop 1
v_add_f32 v148, v148, v149
v_add_f32 v144, v148, v150
v_dot2_f32_bf16 v148, v68, v128, 0
v_dot2_f32_bf16 v149, v72, v132, 0
v_dot2_f32_bf16 v150, v76, v136, 0
s_nop 0
v_dot2c_f32_bf16 v148, v69, v129
v_dot2c_f32_bf16 v149, v73, v133
v_dot2c_f32_bf16 v150, v77, v137
v_dot2c_f32_bf16 v148, v70, v130
v_dot2c_f32_bf16 v149, v74, v134
v_dot2c_f32_bf16 v150, v78, v138
v_dot2c_f32_bf16 v148, v71, v131
v_dot2c_f32_bf16 v149, v75, v135
v_dot2c_f32_bf16 v150, v79, v139
s_nop 1
v_add_f32 v148, v148, v149
v_add_f32 v145, v148, v150
v_dot2_f32_bf16 v148, v80, v128, 0
v_dot2_f32_bf16 v149, v84, v132, 0
v_dot2_f32_bf16 v150, v88, v136, 0
s_nop 0
v_dot2c_f32_bf16 v148, v81, v129
v_dot2c_f32_bf16 v149, v85, v133
v_dot2c_f32_bf16 v150, v89, v137
v_dot2c_f32_bf16 v148, v82, v130
v_dot2c_f32_bf16 v149, v86, v134
v_dot2c_f32_bf16 v150, v90, v138
v_dot2c_f32_bf16 v148, v83, v131
v_dot2c_f32_bf16 v149, v87, v135
v_dot2c_f32_bf16 v150, v91, v139
s_nop 1
v_add_f32 v148, v148, v149
v_add_f32 v146, v148, v150
v_dot2_f32_bf16 v148, v92, v128, 0
v_dot2_f32_bf16 v149, v96, v132, 0
v_dot2_f32_bf16 v150, v100, v136, 0
s_nop 0
v_dot2c_f32_bf16 v148, v93, v129
v_dot2c_f32_bf16 v149, v97, v133
v_dot2c_f32_bf16 v150, v101, v137
v_dot2c_f32_bf16 v148, v94, v130
v_dot2c_f32_bf16 v149, v98, v134
v_dot2c_f32_bf16 v150, v102, v138
v_dot2c_f32_bf16 v148, v95, v131
v_dot2c_f32_bf16 v149, v99, v135
v_dot2c_f32_bf16 v150, v103, v139
s_nop 1
v_add_f32 v148, v148, v149
v_add_f32 v147, v148, v150
v_add_f32_dpp v140, v140, v140 quad_perm:[1,0,3,2] row_mask:0xf bank_mask:0xf
v_add_f32_dpp v141, v141, v141 quad_perm:[1,0,3,2] row_mask:0xf bank_mask:0xf
v_add_f32_dpp v142, v142, v142 quad_perm:[1,0,3,2] row_mask:0xf bank_mask:0xf
v_add_f32_dpp v143, v143, v143 quad_perm:[1,0,3,2] row_mask:0xf bank_mask:0xf
v_add_f32_dpp v144, v144, v144 quad_perm:[1,0,3,2] row_mask:0xf bank_mask:0xf
v_add_f32_dpp v145, v145, v145 quad_perm:[1,0,3,2] row_mask:0xf bank_mask:0xf
v_add_f32_dpp v146, v146, v146 quad_perm:[1,0,3,2] row_mask:0xf bank_mask:0xf
v_add_f32_dpp v147, v147, v147 quad_perm:[1,0,3,2] row_mask:0xf bank_mask:0xf
v_add_f32_dpp v140, v140, v140 quad_perm:[2,3,0,1] row_mask:0xf bank_mask:0xf
v_add_f32_dpp v141, v141, v141 quad_perm:[2,3,0,1] row_mask:0xf bank_mask:0xf
v_add_f32_dpp v142, v142, v142 quad_perm:[2,3,0,1] row_mask:0xf bank_mask:0xf
v_add_f32_dpp v143, v143, v143 quad_perm:[2,3,0,1] row_mask:0xf bank_mask:0xf
v_add_f32_dpp v144, v144, v144 quad_perm:[2,3,0,1] row_mask:0xf bank_mask:0xf
v_add_f32_dpp v145, v145, v145 quad_perm:[2,3,0,1] row_mask:0xf bank_mask:0xf
v_add_f32_dpp v146, v146, v146 quad_perm:[2,3,0,1] row_mask:0xf bank_mask:0xf
v_add_f32_dpp v147, v147, v147 quad_perm:[2,3,0,1] row_mask:0xf bank_mask:0xf
v_add_f32_dpp v140, v140, v140 row_half_mirror row_mask:0xf bank_mask:0xf
v_add_f32_dpp v141, v141, v141 row_half_mirror row_mask:0xf bank_mask:0xf
v_add_f32_dpp v142, v142, v142 row_half_mirror row_mask:0xf bank_mask:0xf
v_add_f32_dpp v143, v143, v143 row_half_mirror row_mask:0xf bank_mask:0xf
v_add_f32_dpp v144, v144, v144 row_half_mirror row_mask:0xf bank_mask:0xf
v_add_f32_dpp v145, v145, v145 row_half_mirror row_mask:0xf bank_mask:0xf
v_add_f32_dpp v146, v146, v146 row_half_mirror row_mask:0xf bank_mask:0xf
v_add_f32_dpp v147, v147, v147 row_half_mirror row_mask:0xf bank_mask:0xf
s_mov_b32 s84, 1033096506
s_mov_b32 s85, 0xffff0000
s_mov_b32 s88, 1069066811
v_cvt_pk_bf16_f32 v148, v140, v141
v_lshlrev_b32 v140, 16, v148
v_and_b32 v141, s85, v148
v_mul_f32 v140, s84, v140
v_mul_f32 v141, s84, v141
v_cvt_pk_bf16_f32 v148, v140, v141
v_lshlrev_b32 v140, 16, v148
v_and_b32 v141, s85, v148
v_cvt_pk_bf16_f32 v148, v142, v143
v_lshlrev_b32 v142, 16, v148
v_and_b32 v143, s85, v148
v_mul_f32 v142, s84, v142
v_mul_f32 v143, s84, v143
v_cvt_pk_bf16_f32 v148, v142, v143
v_lshlrev_b32 v142, 16, v148
v_and_b32 v143, s85, v148
v_cvt_pk_bf16_f32 v148, v144, v145
v_lshlrev_b32 v144, 16, v148
v_and_b32 v145, s85, v148
v_mul_f32 v144, s84, v144
v_mul_f32 v145, s84, v145
v_cvt_pk_bf16_f32 v148, v144, v145
v_lshlrev_b32 v144, 16, v148
v_and_b32 v145, s85, v148
v_cvt_pk_bf16_f32 v148, v146, v147
v_lshlrev_b32 v146, 16, v148
v_and_b32 v147, s85, v148
v_mul_f32 v146, s84, v146
v_mul_f32 v147, s84, v147
v_cvt_pk_bf16_f32 v148, v146, v147
v_lshlrev_b32 v146, 16, v148
v_and_b32 v147, s85, v148
v_max3_f32 v148, v140, v141, v142
v_max3_f32 v148, v148, v143, v144
v_max3_f32 v148, v148, v145, v146
v_max_f32 v148, v148, v147
s_nop 1
v_max_f32_dpp v148, v148, v148 row_ror:8 row_mask:0xf bank_mask:0xf
s_nop 1
v_max_f32_dpp v148, v148, v148 row_bcast:15 row_mask:0xa bank_mask:0xf
s_nop 1
v_max_f32_dpp v148, v148, v148 row_bcast:31 row_mask:0xc bank_mask:0xf
s_nop 0
v_readlane_b32 s89, v148, 63
s_lshl_b32 s84, s3, 2
v_mov_b32 v152, s84
v_mov_b32 v7, 1
v_mov_b32 v150, s89
s_mov_b64 exec, 1
ds_write_b32 v152, v150 offset:896
s_waitcnt lgkmcnt(0)
ds_add_u32 v6, v7 offset:40
s_mov_b64 exec, -1
L_mspin:
ds_read_b32 v7, v6 offset:40
s_waitcnt lgkmcnt(0)
v_readfirstlane_b32 s84, v7
s_nop 1
s_cmp_ge_u32 s84, 8
s_cbranch_scc1 L_mspin_d
s_sleep 1
s_branch L_mspin
L_mspin_d:
ds_read_b128 v[128:131], v6 offset:896
ds_read_b128 v[132:135], v6 offset:912
s_waitcnt lgkmcnt(0)
v_max3_f32 v150, v128, v129, v130
v_max3_f32 v150, v150, v131, v132
v_max3_f32 v150, v150, v133, v134
v_max_f32 v150, v150, v135
v_mov_b32 v149, 0
v_sub_f32 v140, v140, v150
v_mul_f32 v140, s88, v140
v_exp_f32 v140, v140
v_sub_f32 v141, v141, v150
v_mul_f32 v141, s88, v141
v_exp_f32 v141, v141
v_sub_f32 v142, v142, v150
v_mul_f32 v142, s88, v142
v_exp_f32 v142, v142
v_sub_f32 v143, v143, v150
v_mul_f32 v143, s88, v143
v_exp_f32 v143, v143
v_sub_f32 v144, v144, v150
v_mul_f32 v144, s88, v144
v_exp_f32 v144, v144
v_sub_f32 v145, v145, v150
v_mul_f32 v145, s88, v145
v_exp_f32 v145, v145
v_sub_f32 v146, v146, v150
v_mul_f32 v146, s88, v146
v_exp_f32 v146, v146
v_sub_f32 v147, v147, v150
v_mul_f32 v147, s88, v147
v_exp_f32 v147, v147
v_add_f32 v149, v149, v140
v_cvt_pk_bf16_f32 v140, v140, 0
v_add_f32 v149, v149, v141
v_cvt_pk_bf16_f32 v141, v141, 0
v_add_f32 v149, v149, v142
v_cvt_pk_bf16_f32 v142, v142, 0
v_add_f32 v149, v149, v143
v_cvt_pk_bf16_f32 v143, v143, 0
v_add_f32 v149, v149, v144
v_cvt_pk_bf16_f32 v144, v144, 0
v_add_f32 v149, v149, v145
v_cvt_pk_bf16_f32 v145, v145, 0
v_add_f32 v149, v149, v146
v_cvt_pk_bf16_f32 v146, v146, 0
v_add_f32 v149, v149, v147
v_cvt_pk_bf16_f32 v147, v147, 0
s_nop 0
v_add_f32_dpp v149, v149, v149 row_ror:8 row_mask:0xf bank_mask:0xf
s_nop 1
v_add_f32_dpp v149, v149, v149 row_bcast:15 row_mask:0xa bank_mask:0xf
s_nop 1
v_add_f32_dpp v149, v149, v149 row_bcast:31 row_mask:0xc bank_mask:0xf
s_nop 0
v_readlane_b32 s91, v149, 63
s_nop 1
v_mov_b32 v151, s91
v_mov_b32 v7, 1
s_mov_b64 exec, 1
ds_write_b32 v152, v151 offset:928
s_waitcnt lgkmcnt(0)
ds_add_u32 v6, v7 offset:12
s_mov_b64 exec, -1
v_lshlrev_b32 v7, 4, v1
v_add_u32 v7, s86, v7
ds_read_b128 v[80:83], v7 offset:0
ds_read_b128 v[84:87], v7 offset:1024
ds_read_b128 v[88:91], v7 offset:2048
ds_read_b128 v[92:95], v7 offset:24576
ds_read_b128 v[96:99], v7 offset:25600
ds_read_b128 v[100:103], v7 offset:26624
s_waitcnt lgkmcnt(3)
v_lshlrev_b32 v148, 16, v140
v_dot2c_f32_bf16 v104, v80, v140
v_dot2c_f32_bf16 v105, v80, v148
v_dot2c_f32_bf16 v106, v81, v140
v_dot2c_f32_bf16 v107, v81, v148
v_dot2c_f32_bf16 v108, v82, v140
v_dot2c_f32_bf16 v109, v82, v148
v_dot2c_f32_bf16 v110, v83, v140
v_dot2c_f32_bf16 v111, v83, v148
v_dot2c_f32_bf16 v112, v84, v140
v_dot2c_f32_bf16 v113, v84, v148
v_dot2c_f32_bf16 v114, v85, v140
v_dot2c_f32_bf16 v115, v85, v148
v_dot2c_f32_bf16 v116, v86, v140
v_dot2c_f32_bf16 v117, v86, v148
v_dot2c_f32_bf16 v118, v87, v140
v_dot2c_f32_bf16 v119, v87, v148
v_dot2c_f32_bf16 v120, v88, v140
v_dot2c_f32_bf16 v121, v88, v148
v_dot2c_f32_bf16 v122, v89, v140
v_dot2c_f32_bf16 v123, v89, v148
v_dot2c_f32_bf16 v124, v90, v140
v_dot2c_f32_bf16 v125, v90, v148
v_dot2c_f32_bf16 v126, v91, v140
v_dot2c_f32_bf16 v127, v91, v148
s_waitcnt lgkmcnt(0)
v_lshlrev_b32 v148, 16, v141
v_dot2c_f32_bf16 v104, v92, v141
v_dot2c_f32_bf16 v105, v92, v148
v_dot2c_f32_bf16 v106, v93, v141
v_dot2c_f32_bf16 v107, v93, v148
v_dot2c_f32_bf16 v108, v94, v141
v_dot2c_f32_bf16 v109, v94, v148
v_dot2c_f32_bf16 v110, v95, v141
v_dot2c_f32_bf16 v111, v95, v148
v_dot2c_f32_bf16 v112, v96, v141
v_dot2c_f32_bf16 v113, v96, v148
v_dot2c_f32_bf16 v114, v97, v141
v_dot2c_f32_bf16 v115, v97, v148
v_dot2c_f32_bf16 v116, v98, v141
v_dot2c_f32_bf16 v117, v98, v148
v_dot2c_f32_bf16 v118, v99, v141
v_dot2c_f32_bf16 v119, v99, v148
v_dot2c_f32_bf16 v120, v100, v141
v_dot2c_f32_bf16 v121, v100, v148
v_dot2c_f32_bf16 v122, v101, v141
v_dot2c_f32_bf16 v123, v101, v148
v_dot2c_f32_bf16 v124, v102, v141
v_dot2c_f32_bf16 v125, v102, v148
v_dot2c_f32_bf16 v126, v103, v141
v_dot2c_f32_bf16 v127, v103, v148
v_lshrrev_b32 v153, 4, v1
v_mul_u32_u24 v153, 192, v153
v_lshlrev_b32 v154, 2, v3
v_add_u32 v153, v153, v154
s_mul_i32 s84, s3, 768
v_add_u32 v153, s84, v153
s_waitcnt vmcnt(3)
s_mov_b32 s84, 98304
buffer_load_dwordx4 v[32:35], v2, s[48:51], s84 offen offset:0 nt
buffer_load_dwordx4 v[36:39], v2, s[48:51], s84 offen offset:128 nt
buffer_load_dwordx4 v[40:43], v2, s[48:51], s84 offen offset:256 nt
v_lshlrev_b32 v148, 16, v142
v_dot2c_f32_bf16 v104, v8, v142
v_dot2c_f32_bf16 v105, v8, v148
v_dot2c_f32_bf16 v106, v9, v142
v_dot2c_f32_bf16 v107, v9, v148
v_dot2c_f32_bf16 v108, v10, v142
v_dot2c_f32_bf16 v109, v10, v148
v_dot2c_f32_bf16 v110, v11, v142
v_dot2c_f32_bf16 v111, v11, v148
v_dot2c_f32_bf16 v112, v12, v142
v_dot2c_f32_bf16 v113, v12, v148
v_dot2c_f32_bf16 v114, v13, v142
v_dot2c_f32_bf16 v115, v13, v148
v_dot2c_f32_bf16 v116, v14, v142
v_dot2c_f32_bf16 v117, v14, v148
v_dot2c_f32_bf16 v118, v15, v142
v_dot2c_f32_bf16 v119, v15, v148
v_dot2c_f32_bf16 v120, v16, v142
v_dot2c_f32_bf16 v121, v16, v148
v_dot2c_f32_bf16 v122, v17, v142
v_dot2c_f32_bf16 v123, v17, v148
v_dot2c_f32_bf16 v124, v18, v142
v_dot2c_f32_bf16 v125, v18, v148
v_dot2c_f32_bf16 v126, v19, v142
v_dot2c_f32_bf16 v127, v19, v148
s_waitcnt vmcnt(3)
s_mov_b32 s84, 122880
buffer_load_dwordx4 v[44:47], v2, s[48:51], s84 offen offset:0 nt
buffer_load_dwordx4 v[48:51], v2, s[48:51], s84 offen offset:128 nt
buffer_load_dwordx4 v[52:55], v2, s[48:51], s84 offen offset:256 nt
v_lshlrev_b32 v148, 16, v143
v_dot2c_f32_bf16 v104, v20, v143
v_dot2c_f32_bf16 v105, v20, v148
v_dot2c_f32_bf16 v106, v21, v143
v_dot2c_f32_bf16 v107, v21, v148
v_dot2c_f32_bf16 v108, v22, v143
v_dot2c_f32_bf16 v109, v22, v148
v_dot2c_f32_bf16 v110, v23, v143
v_dot2c_f32_bf16 v111, v23, v148
v_dot2c_f32_bf16 v112, v24, v143
v_dot2c_f32_bf16 v113, v24, v148
v_dot2c_f32_bf16 v114, v25, v143
v_dot2c_f32_bf16 v115, v25, v148
v_dot2c_f32_bf16 v116, v26, v143
v_dot2c_f32_bf16 v117, v26, v148
v_dot2c_f32_bf16 v118, v27, v143
v_dot2c_f32_bf16 v119, v27, v148
v_dot2c_f32_bf16 v120, v28, v143
v_dot2c_f32_bf16 v121, v28, v148
v_dot2c_f32_bf16 v122, v29, v143
v_dot2c_f32_bf16 v123, v29, v148
v_dot2c_f32_bf16 v124, v30, v143
v_dot2c_f32_bf16 v125, v30, v148
v_dot2c_f32_bf16 v126, v31, v143
v_dot2c_f32_bf16 v127, v31, v148
s_waitcnt vmcnt(3)
s_mov_b32 s84, 147456
buffer_load_dwordx4 v[56:59], v2, s[48:51], s84 offen offset:0 nt
buffer_load_dwordx4 v[60:63], v2, s[48:51], s84 offen offset:128 nt
buffer_load_dwordx4 v[64:67], v2, s[48:51], s84 offen offset:256 nt
v_lshlrev_b32 v148, 16, v144
v_dot2c_f32_bf16 v104, v32, v144
v_dot2c_f32_bf16 v105, v32, v148
v_dot2c_f32_bf16 v106, v33, v144
v_dot2c_f32_bf16 v107, v33, v148
v_dot2c_f32_bf16 v108, v34, v144
v_dot2c_f32_bf16 v109, v34, v148
v_dot2c_f32_bf16 v110, v35, v144
v_dot2c_f32_bf16 v111, v35, v148
v_dot2c_f32_bf16 v112, v36, v144
v_dot2c_f32_bf16 v113, v36, v148
v_dot2c_f32_bf16 v114, v37, v144
v_dot2c_f32_bf16 v115, v37, v148
v_dot2c_f32_bf16 v116, v38, v144
v_dot2c_f32_bf16 v117, v38, v148
v_dot2c_f32_bf16 v118, v39, v144
v_dot2c_f32_bf16 v119, v39, v148
v_dot2c_f32_bf16 v120, v40, v144
v_dot2c_f32_bf16 v121, v40, v148
v_dot2c_f32_bf16 v122, v41, v144
v_dot2c_f32_bf16 v123, v41, v148
v_dot2c_f32_bf16 v124, v42, v144
v_dot2c_f32_bf16 v125, v42, v148
v_dot2c_f32_bf16 v126, v43, v144
v_dot2c_f32_bf16 v127, v43, v148
s_waitcnt vmcnt(3)
s_mov_b32 s84, 172032
buffer_load_dwordx4 v[68:71], v2, s[48:51], s84 offen offset:0 nt
buffer_load_dwordx4 v[72:75], v2, s[48:51], s84 offen offset:128 nt
buffer_load_dwordx4 v[76:79], v2, s[48:51], s84 offen offset:256 nt
v_mov_b32 v7, 1
s_mov_b64 exec, 1
ds_add_u32 v6, v7 offset:28
s_mov_b64 exec, -1
v_lshlrev_b32 v148, 16, v145
v_dot2c_f32_bf16 v104, v44, v145
v_dot2c_f32_bf16 v105, v44, v148
v_dot2c_f32_bf16 v106, v45, v145
v_dot2c_f32_bf16 v107, v45, v148
v_dot2c_f32_bf16 v108, v46, v145
v_dot2c_f32_bf16 v109, v46, v148
v_dot2c_f32_bf16 v110, v47, v145
v_dot2c_f32_bf16 v111, v47, v148
v_dot2c_f32_bf16 v112, v48, v145
v_dot2c_f32_bf16 v113, v48, v148
v_dot2c_f32_bf16 v114, v49, v145
v_dot2c_f32_bf16 v115, v49, v148
v_dot2c_f32_bf16 v116, v50, v145
v_dot2c_f32_bf16 v117, v50, v148
v_dot2c_f32_bf16 v118, v51, v145
v_dot2c_f32_bf16 v119, v51, v148
v_dot2c_f32_bf16 v120, v52, v145
v_dot2c_f32_bf16 v121, v52, v148
v_dot2c_f32_bf16 v122, v53, v145
v_dot2c_f32_bf16 v123, v53, v148
v_dot2c_f32_bf16 v124, v54, v145
v_dot2c_f32_bf16 v125, v54, v148
v_dot2c_f32_bf16 v126, v55, v145
v_dot2c_f32_bf16 v127, v55, v148
s_waitcnt vmcnt(3)
v_lshlrev_b32 v148, 16, v146
v_dot2c_f32_bf16 v104, v56, v146
v_dot2c_f32_bf16 v105, v56, v148
v_dot2c_f32_bf16 v106, v57, v146
v_dot2c_f32_bf16 v107, v57, v148
v_dot2c_f32_bf16 v108, v58, v146
v_dot2c_f32_bf16 v109, v58, v148
v_dot2c_f32_bf16 v110, v59, v146
v_dot2c_f32_bf16 v111, v59, v148
v_dot2c_f32_bf16 v112, v60, v146
v_dot2c_f32_bf16 v113, v60, v148
v_dot2c_f32_bf16 v114, v61, v146
v_dot2c_f32_bf16 v115, v61, v148
v_dot2c_f32_bf16 v116, v62, v146
v_dot2c_f32_bf16 v117, v62, v148
v_dot2c_f32_bf16 v118, v63, v146
v_dot2c_f32_bf16 v119, v63, v148
v_dot2c_f32_bf16 v120, v64, v146
v_dot2c_f32_bf16 v121, v64, v148
v_dot2c_f32_bf16 v122, v65, v146
v_dot2c_f32_bf16 v123, v65, v148
v_dot2c_f32_bf16 v124, v66, v146
v_dot2c_f32_bf16 v125, v66, v148
v_dot2c_f32_bf16 v126, v67, v146
v_dot2c_f32_bf16 v127, v67, v148
s_waitcnt vmcnt(0)
v_lshlrev_b32 v148, 16, v147
v_dot2c_f32_bf16 v104, v68, v147
v_dot2c_f32_bf16 v105, v68, v148
v_dot2c_f32_bf16 v106, v69, v147
v_dot2c_f32_bf16 v107, v69, v148
v_dot2c_f32_bf16 v108, v70, v147
v_dot2c_f32_bf16 v109, v70, v148
v_dot2c_f32_bf16 v110, v71, v147
v_dot2c_f32_bf16 v111, v71, v148
v_dot2c_f32_bf16 v112, v72, v147
v_dot2c_f32_bf16 v113, v72, v148
v_dot2c_f32_bf16 v114, v73, v147
v_dot2c_f32_bf16 v115, v73, v148
v_dot2c_f32_bf16 v116, v74, v147
v_dot2c_f32_bf16 v117, v74, v148
v_dot2c_f32_bf16 v118, v75, v147
v_dot2c_f32_bf16 v119, v75, v148
v_dot2c_f32_bf16 v120, v76, v147
v_dot2c_f32_bf16 v121, v76, v148
v_dot2c_f32_bf16 v122, v77, v147
v_dot2c_f32_bf16 v123, v77, v148
v_dot2c_f32_bf16 v124, v78, v147
v_dot2c_f32_bf16 v125, v78, v148
v_dot2c_f32_bf16 v126, v79, v147
v_dot2c_f32_bf16 v127, v79, v148
v_permlane32_swap_b32 v104, v116
v_permlane32_swap_b32 v105, v117
v_permlane32_swap_b32 v106, v118
v_permlane32_swap_b32 v107, v119
v_permlane32_swap_b32 v108, v120
v_permlane32_swap_b32 v109, v121
v_permlane32_swap_b32 v110, v122
v_permlane32_swap_b32 v111, v123
v_permlane32_swap_b32 v112, v124
v_permlane32_swap_b32 v113, v125
v_permlane32_swap_b32 v114, v126
v_permlane32_swap_b32 v115, v127
v_add_f32 v104, v104, v116
v_add_f32 v105, v105, v117
v_add_f32 v106, v106, v118
v_add_f32 v107, v107, v119
v_add_f32 v108, v108, v120
v_add_f32 v109, v109, v121
v_add_f32 v110, v110, v122
v_add_f32 v111, v111, v123
v_add_f32 v112, v112, v124
v_add_f32 v113, v113, v125
v_add_f32 v114, v114, v126
v_add_f32 v115, v115, v127
v_permlane16_swap_b32 v104, v110
v_permlane16_swap_b32 v105, v111
v_permlane16_swap_b32 v106, v112
v_permlane16_swap_b32 v107, v113
v_permlane16_swap_b32 v108, v114
v_permlane16_swap_b32 v109, v115
v_add_f32 v104, v104, v110
v_add_f32 v105, v105, v111
v_add_f32 v106, v106, v112
v_add_f32 v107, v107, v113
v_add_f32 v108, v108, v114
v_add_f32 v109, v109, v115
v_add_f32_dpp v104, v104, v104 row_ror:8 row_mask:0xf bank_mask:0xf
v_add_f32_dpp v105, v105, v105 row_ror:8 row_mask:0xf bank_mask:0xf
v_add_f32_dpp v106, v106, v106 row_ror:8 row_mask:0xf bank_mask:0xf
v_add_f32_dpp v107, v107, v107 row_ror:8 row_mask:0xf bank_mask:0xf
v_add_f32_dpp v108, v108, v108 row_ror:8 row_mask:0xf bank_mask:0xf
v_add_f32_dpp v109, v109, v109 row_ror:8 row_mask:0xf bank_mask:0xf
ds_write_b32 v153, v104 offset:12288
ds_write_b32 v153, v105 offset:12320
ds_write_b32 v153, v106 offset:12352
ds_write_b32 v153, v107 offset:12384
ds_write_b32 v153, v108 offset:12416
ds_write_b32 v153, v109 offset:12448
v_mov_b32 v6, 0
v_mov_b32 v7, 1
s_mov_b64 exec, 1
ds_add_u32 v6, v7 offset:44
s_mov_b64 exec, -1
s_cmp_ge_u32 s3, 3
s_cbranch_scc1 L_tail
L_ofr:
ds_read_b32 v7, v6 offset:56
s_waitcnt lgkmcnt(0)
v_readfirstlane_b32 s84, v7
s_nop 1
s_cmp_ge_u32 s84, 1
s_cbranch_scc1 L_ofr_d
s_sleep 1
s_branch L_ofr
L_ofr_d:
v_lshlrev_b32 v5, 2, v0
v_and_b32 v16, 0xc0, v0
v_and_b32 v17, 7, v0
v_lshlrev_b32 v17, 3, v17
v_add_u32 v16, v16, v17
v_bfe_u32 v17, v0, 3, 3
v_add_u32 v16, v16, v17
v_lshlrev_b32 v16, 2, v16
s_mul_i32 s88, s4, 24576
s_mul_i32 s85, s5, 768
s_add_u32 s88, s88, s85
s_add_u32 s88, s88, 71680
L_ospin:
ds_read_b32 v7, v6 offset:44
s_waitcnt lgkmcnt(0)
v_readfirstlane_b32 s84, v7
s_nop 1
s_cmp_ge_u32 s84, 8
s_cbranch_scc1 L_ospin_d
s_branch L_ospin
L_ospin_d:
ds_read_b32 v8, v5 offset:12288
ds_read_b32 v9, v5 offset:13056
ds_read_b32 v10, v5 offset:13824
ds_read_b32 v11, v5 offset:14592
ds_read_b32 v12, v5 offset:15360
ds_read_b32 v13, v5 offset:16128
ds_read_b32 v14, v5 offset:16896
ds_read_b32 v15, v5 offset:17664
s_waitcnt lgkmcnt(4)
v_add_f32 v8, v8, v9
v_add_f32 v10, v10, v11
v_add_f32 v8, v8, v10
s_waitcnt lgkmcnt(0)
v_add_f32 v12, v12, v13
v_add_f32 v14, v14, v15
v_add_f32 v12, v12, v14
v_add_f32 v8, v8, v12
v_min_u32 v8, -2, v8
buffer_store_dword v8, v16, s[52:55], s88 offen sc1
v_mov_b32 v6, 0
v_mov_b32 v7, 1
s_mov_b64 exec, 1
ds_add_u32 v6, v7 offset:60
s_mov_b64 exec, -1
s_branch L_tail
L_helper:
s_setprio 2
s_sub_u32 s91, s3, 8
v_lshlrev_b32 v2, 3, v1
s_mul_i32 s84, s8, 320
buffer_load_dwordx2 v[8:9], v2, s[72:75], s84 offen
v_lshlrev_b32 v3, 4, v1
buffer_load_dwordx4 v[12:15], v3, s[68:71], 0 offen
buffer_load_dwordx4 v[16:19], v3, s[68:71], 0 offen offset:1024
s_mul_i32 s84, s4, 160
v_lshlrev_b32 v4, 2, v1
buffer_load_dword v20, v4, s[68:71], s84 offen
v_lshrrev_b32 v5, 3, v1
v_and_b32 v6, 7, v1
v_lshlrev_b32 v6, 4, v6
v_mul_u32_u24 v7, 7680, v5
v_add_u32 v7, v7, v6
s_cmp_ge_u32 s2, 240
s_cbranch_scc1 L_h_clr
s_mul_i32 s84, s8, 160
s_mul_i32 s85, s91, 40
s_add_u32 s84, s84, s85
s_mul_i32 s84, s84, 7680
s_lshl_b32 s88, s9, 7
s_add_u32 s84, s84, s88
s_mul_i32 s85, s91, 5120
s_add_u32 s85, s85, 43008
s_mov_b32 m0, s85
s_nop 0
buffer_load_dwordx4 v7, s[64:67], s84 offen nt lds
s_add_u32 s84, s84, 61440
s_add_u32 s85, s85, 1024
s_mov_b32 m0, s85
s_nop 0
buffer_load_dwordx4 v7, s[64:67], s84 offen nt lds
s_add_u32 s84, s84, 61440
s_add_u32 s85, s85, 1024
s_mov_b32 m0, s85
s_nop 0
buffer_load_dwordx4 v7, s[64:67], s84 offen nt lds
s_add_u32 s84, s84, 61440
s_add_u32 s85, s85, 1024
s_mov_b32 m0, s85
s_nop 0
buffer_load_dwordx4 v7, s[64:67], s84 offen nt lds
s_add_u32 s84, s84, 61440
s_add_u32 s85, s85, 1024
s_mov_b32 m0, s85
s_nop 0
buffer_load_dwordx4 v7, s[64:67], s84 offen nt lds
s_branch L_h_nom1
L_h_clr:
L_h_nom1:
v_add_u32 v22, 0, v1
v_mul_u32_u24 v23, 2731, v22
v_lshrrev_b32 v23, 16, v23
v_mul_u32_u24 v24, 24, v23
v_sub_u32 v24, v22, v24
v_lshlrev_b32 v24, 4, v24
v_mul_u32_u24 v23, 12288, v23
v_add_u32 v25, v23, v24
v_add_u32 v22, 64, v1
v_mul_u32_u24 v23, 2731, v22
v_lshrrev_b32 v23, 16, v23
v_mul_u32_u24 v24, 24, v23
v_sub_u32 v24, v22, v24
v_lshlrev_b32 v24, 4, v24
v_mul_u32_u24 v23, 12288, v23
v_add_u32 v26, v23, v24
v_add_u32 v22, 128, v1
v_mul_u32_u24 v23, 2731, v22
v_lshrrev_b32 v23, 16, v23
v_mul_u32_u24 v24, 24, v23
v_sub_u32 v24, v22, v24
v_lshlrev_b32 v24, 4, v24
v_mul_u32_u24 v23, 12288, v23
v_add_u32 v27, v23, v24
s_mul_i32 s84, s4, 80
s_mul_i32 s85, s91, 20
s_add_u32 s84, s84, s85
s_mul_i32 s84, s84, 12288
s_mul_i32 s88, s5, 384
s_add_u32 s84, s84, s88
s_mul_i32 s85, s91, 7680
s_add_u32 s85, s85, 12288
s_mov_b32 m0, s85
s_nop 0
buffer_load_dwordx4 v25, s[60:63], s84 offen nt lds
s_add_u32 s85, s85, 1024
s_mov_b32 m0, s85
s_nop 0
buffer_load_dwordx4 v26, s[60:63], s84 offen nt lds
s_add_u32 s85, s85, 1024
s_mov_b32 m0, s85
s_nop 0
buffer_load_dwordx4 v27, s[60:63], s84 offen nt lds
s_add_u32 s85, s85, 1024
s_add_u32 s84, s84, 98304
s_mov_b32 m0, s85
s_nop 0
buffer_load_dwordx4 v25, s[60:63], s84 offen nt lds
s_add_u32 s85, s85, 1024
s_mov_b32 m0, s85
s_nop 0
buffer_load_dwordx4 v26, s[60:63], s84 offen nt lds
s_add_u32 s85, s85, 1024
s_mov_b32 m0, s85
s_nop 0
buffer_load_dwordx4 v27, s[60:63], s84 offen nt lds
s_add_u32 s85, s85, 1024
s_add_u32 s84, s84, 98304
s_mov_b32 m0, s85
s_nop 0
buffer_load_dwordx4 v25, s[60:63], s84 offen nt lds
s_add_u32 s85, s85, 1024
s_mov_b32 exec_hi, 0
s_mov_b32 m0, s85
s_nop 0
buffer_load_dwordx4 v26, s[60:63], s84 offen nt lds
s_mov_b64 exec, -1
v_lshrrev_b32 v28, 4, v1
v_and_b32 v29, 15, v1
v_lshrrev_b32 v30, 2, v29
v_and_b32 v31, 3, v29
v_lshlrev_b32 v31, 3, v31
s_lshl_b32 s85, s91, 9
s_add_u32 s85, s85, 1024
s_cmp_lt_u32 s2, 240
s_cbranch_scc1 L_h_dom
v_mov_b32 v35, 0
v_mov_b32 v36, 1
s_waitcnt vmcnt(5)
s_mov_b64 exec, 1
ds_add_u32 v35, v36 offset:0
s_mov_b64 exec, -1
s_sub_u32 s84, s91, 1
s_cmp_ge_u32 s84, 2
s_cbranch_scc1 L_h_noclr2
v_mov_b32 v40, -1
v_mov_b32 v41, -1
v_mov_b32 v42, -1
v_mov_b32 v43, -1
s_sub_u32 s88, s2, 240
s_lshl_b32 s88, s88, 1
s_add_u32 s84, s84, s88
s_mul_i32 s84, s84, 11264
buffer_store_dwordx4 v[40:43], v3, s[52:55], s84 offen sc1
s_add_u32 s84, s84, 1024
buffer_store_dwordx4 v[40:43], v3, s[52:55], s84 offen sc1
s_add_u32 s84, s84, 1024
buffer_store_dwordx4 v[40:43], v3, s[52:55], s84 offen sc1
s_add_u32 s84, s84, 1024
buffer_store_dwordx4 v[40:43], v3, s[52:55], s84 offen sc1
s_add_u32 s84, s84, 1024
buffer_store_dwordx4 v[40:43], v3, s[52:55], s84 offen sc1
s_add_u32 s84, s84, 1024
buffer_store_dwordx4 v[40:43], v3, s[52:55], s84 offen sc1
s_add_u32 s84, s84, 1024
buffer_store_dwordx4 v[40:43], v3, s[52:55], s84 offen sc1
s_add_u32 s84, s84, 1024
buffer_store_dwordx4 v[40:43], v3, s[52:55], s84 offen sc1
s_add_u32 s84, s84, 1024
buffer_store_dwordx4 v[40:43], v3, s[52:55], s84 offen sc1
s_add_u32 s84, s84, 1024
buffer_store_dwordx4 v[40:43], v3, s[52:55], s84 offen sc1
s_add_u32 s84, s84, 1024
buffer_store_dwordx4 v[40:43], v3, s[52:55], s84 offen sc1
L_h_noclr2:
s_branch L_h_nom2
L_h_dom:
s_waitcnt vmcnt(16)
s_mov_b32 s84, 1069066811
v_lshlrev_b32 v32, 16, v8
v_and_b32 v33, 0xffff0000, v8
v_lshlrev_b32 v34, 16, v9
v_and_b32 v35, 0xffff0000, v9
v_mul_f32 v36, s84, v32
v_exp_f32 v36, -v36
s_nop 0
v_add_f32 v36, 1.0, v36
v_rcp_f32 v44, v36
s_nop 0
v_mul_f32 v40, v32, v44
v_fma_f32 v45, -v40, v36, v32
v_fma_f32 v40, v45, v44, v40
v_mul_f32 v37, s84, v33
v_exp_f32 v37, -v37
s_nop 0
v_add_f32 v37, 1.0, v37
v_rcp_f32 v44, v37
s_nop 0
v_mul_f32 v41, v33, v44
v_fma_f32 v45, -v41, v37, v33
v_fma_f32 v41, v45, v44, v41
v_mul_f32 v38, s84, v34
v_exp_f32 v38, -v38
s_nop 0
v_add_f32 v38, 1.0, v38
v_rcp_f32 v44, v38
s_nop 0
v_mul_f32 v42, v34, v44
v_fma_f32 v45, -v42, v38, v34
v_fma_f32 v42, v45, v44, v42
v_mul_f32 v39, s84, v35
v_exp_f32 v39, -v39
s_nop 0
v_add_f32 v39, 1.0, v39
v_rcp_f32 v44, v39
s_nop 0
v_mul_f32 v43, v35, v44
v_fma_f32 v45, -v43, v39, v35
v_fma_f32 v43, v45, v44, v43
v_cvt_pk_bf16_f32 v32, v40, v41
v_cvt_pk_bf16_f32 v33, v42, v43
v_add_u32 v34, s85, v2
s_mov_b32 exec_hi, 0xff
ds_write_b64 v34, v[32:33]
s_mov_b64 exec, -1
v_lshlrev_b32 v34, 4, v28
v_add_u32 v34, s85, v34
s_waitcnt lgkmcnt(0)
ds_read_b128 v[48:51], v34 offset:0
ds_read_b128 v[52:55], v34 offset:64
ds_read_b128 v[56:59], v34 offset:128
ds_read_b128 v[60:63], v34 offset:192
ds_read_b128 v[64:67], v34 offset:256
s_waitcnt vmcnt(8)
v_mov_b32 v35, 0
v_mov_b32 v36, 1
s_mov_b64 exec, 1
ds_add_u32 v35, v36 offset:0
s_mov_b64 exec, -1
L_h_syncm:
ds_read_b32 v36, v35 offset:0
s_waitcnt lgkmcnt(0)
v_readfirstlane_b32 s84, v36
s_nop 1
s_cmp_lt_u32 s84, 4
s_cbranch_scc1 L_h_syncm
v_lshlrev_b32 v34, 3, v28
v_add_u32 v34, v34, v30
v_lshlrev_b32 v34, 7, v34
v_add_u32 v34, v34, v31
s_lshl_b32 s84, s91, 5
s_add_u32 s84, s84, 43008
v_add_u32 v34, s84, v34
ds_read_b64_tr_b16 v[68:69], v34 offset:0
ds_read_b64_tr_b16 v[70:71], v34 offset:512
ds_read_b64_tr_b16 v[72:73], v34 offset:4096
ds_read_b64_tr_b16 v[74:75], v34 offset:4608
ds_read_b64_tr_b16 v[76:77], v34 offset:8192
ds_read_b64_tr_b16 v[78:79], v34 offset:8704
ds_read_b64_tr_b16 v[80:81], v34 offset:12288
ds_read_b64_tr_b16 v[82:83], v34 offset:12800
ds_read_b64_tr_b16 v[84:85], v34 offset:16384
ds_read_b64_tr_b16 v[86:87], v34 offset:16896
s_waitcnt lgkmcnt(0)
v_mfma_f32_16x16x32_bf16 v[88:91], v[48:51], v[68:71], 0
v_mfma_f32_16x16x32_bf16 v[88:91], v[52:55], v[72:75], v[88:91]
v_mfma_f32_16x16x32_bf16 v[88:91], v[56:59], v[76:79], v[88:91]
v_mfma_f32_16x16x32_bf16 v[88:91], v[60:63], v[80:83], v[88:91]
v_mfma_f32_16x16x32_bf16 v[88:91], v[64:67], v[84:87], v[88:91]
s_nop 7
v_min_u32 v88, -2, v88
s_lshl_b32 s88, s91, 6
v_lshlrev_b32 v34, 2, v1
v_add_u32 v34, s88, v34
s_mov_b64 exec, 0xffff
ds_write_b32 v34, v88 offset:640
s_waitcnt lgkmcnt(0)
v_mov_b32 v35, 0
v_mov_b32 v36, 1
s_mov_b64 exec, 1
ds_add_u32 v35, v36 offset:36
s_mov_b64 exec, -1
L_h_nom2:
s_cmp_lg_u32 s91, 3
s_cbranch_scc1 L_h_nomst
s_cmp_ge_u32 s2, 240
s_cbranch_scc1 L_h_nomst
v_mov_b32 v35, 0
L_h_mtspin:
ds_read_b32 v36, v35 offset:36
s_waitcnt lgkmcnt(0)
v_readfirstlane_b32 s84, v36
s_nop 1
s_cmp_ge_u32 s84, 4
s_cbranch_scc1 L_h_mtspin_d
s_sleep 1
s_branch L_h_mtspin
L_h_mtspin_d:
ds_read_b32 v38, v4 offset:640
s_mul_i32 s84, s8, 30720
s_lshl_b32 s88, s9, 9
s_add_u32 s84, s84, s88
s_add_u32 s84, s84, 360448
v_mov_b32 v39, s42
s_waitcnt lgkmcnt(0)
buffer_store_dwordx2 v[38:39], v2, s[52:55], s84 offen sc1
L_h_nomst:
s_cmp_ge_u32 s91, 2
s_cbranch_scc1 L_h_wq
s_waitcnt vmcnt(8)
v_lshlrev_b32 v32, 16, v12
v_and_b32 v33, 0xffff0000, v12
v_lshlrev_b32 v40, 16, v16
v_and_b32 v41, 0xffff0000, v16
v_lshlrev_b32 v34, 16, v13
v_and_b32 v35, 0xffff0000, v13
v_lshlrev_b32 v42, 16, v17
v_and_b32 v43, 0xffff0000, v17
v_lshlrev_b32 v36, 16, v14
v_and_b32 v37, 0xffff0000, v14
v_lshlrev_b32 v44, 16, v18
v_and_b32 v45, 0xffff0000, v18
v_lshlrev_b32 v38, 16, v15
v_and_b32 v39, 0xffff0000, v15
v_lshlrev_b32 v46, 16, v19
v_and_b32 v47, 0xffff0000, v19
s_cmp_eq_u32 s91, 1
s_cbranch_scc0 L_h_ln
v_lshlrev_b32 v50, 5, v1
ds_write_b128 v50, v[32:35] offset:9216
ds_write_b128 v50, v[36:39] offset:9232
s_mov_b64 exec, 0xffff
ds_write_b128 v50, v[40:43] offset:11264
ds_write_b128 v50, v[44:47] offset:11280
s_mov_b64 exec, -1
s_branch L_h_wq
L_h_ln:
v_add_f32 v48, v32, v33
v_add_f32 v48, v48, v34
v_add_f32 v48, v48, v35
v_add_f32 v48, v48, v36
v_add_f32 v48, v48, v37
v_add_f32 v48, v48, v38
v_add_f32 v48, v48, v39
v_add_f32 v48, v48, v40
v_add_f32 v48, v48, v41
v_add_f32 v48, v48, v42
v_add_f32 v48, v48, v43
v_add_f32 v48, v48, v44
v_add_f32 v48, v48, v45
v_add_f32 v48, v48, v46
v_add_f32 v48, v48, v47
s_nop 1
v_add_f32_dpp v48, v48, v48 quad_perm:[1,0,3,2] row_mask:0xf bank_mask:0xf
s_nop 1
v_add_f32_dpp v48, v48, v48 quad_perm:[2,3,0,1] row_mask:0xf bank_mask:0xf
s_nop 1
v_add_f32_dpp v48, v48, v48 row_half_mirror row_mask:0xf bank_mask:0xf
s_nop 1
v_add_f32_dpp v48, v48, v48 row_ror:8 row_mask:0xf bank_mask:0xf
s_nop 1
v_add_f32_dpp v48, v48, v48 row_bcast:15 row_mask:0xa bank_mask:0xf
s_nop 1
v_add_f32_dpp v48, v48, v48 row_bcast:31 row_mask:0xc bank_mask:0xf
s_nop 0
v_readlane_b32 s84, v48, 63
v_mov_b32 v49, 986500301
s_nop 0
v_mul_f32 v49, s84, v49
v_cmp_gt_u32 vcc, 16, v1
s_nop 1
v_cndmask_b32 v40, v49, v40, vcc
v_cndmask_b32 v41, v49, v41, vcc
v_cndmask_b32 v42, v49, v42, vcc
v_cndmask_b32 v43, v49, v43, vcc
v_cndmask_b32 v44, v49, v44, vcc
v_cndmask_b32 v45, v49, v45, vcc
v_cndmask_b32 v46, v49, v46, vcc
v_cndmask_b32 v47, v49, v47, vcc
v_mov_b32 v48, 0
v_sub_f32 v50, v32, v49
v_fmac_f32 v48, v50, v50
v_sub_f32 v50, v33, v49
v_fmac_f32 v48, v50, v50
v_sub_f32 v50, v34, v49
v_fmac_f32 v48, v50, v50
v_sub_f32 v50, v35, v49
v_fmac_f32 v48, v50, v50
v_sub_f32 v50, v36, v49
v_fmac_f32 v48, v50, v50
v_sub_f32 v50, v37, v49
v_fmac_f32 v48, v50, v50
v_sub_f32 v50, v38, v49
v_fmac_f32 v48, v50, v50
v_sub_f32 v50, v39, v49
v_fmac_f32 v48, v50, v50
v_sub_f32 v50, v40, v49
v_fmac_f32 v48, v50, v50
v_sub_f32 v50, v41, v49
v_fmac_f32 v48, v50, v50
v_sub_f32 v50, v42, v49
v_fmac_f32 v48, v50, v50
v_sub_f32 v50, v43, v49
v_fmac_f32 v48, v50, v50
v_sub_f32 v50, v44, v49
v_fmac_f32 v48, v50, v50
v_sub_f32 v50, v45, v49
v_fmac_f32 v48, v50, v50
v_sub_f32 v50, v46, v49
v_fmac_f32 v48, v50, v50
v_sub_f32 v50, v47, v49
v_fmac_f32 v48, v50, v50
s_nop 1
v_add_f32_dpp v48, v48, v48 quad_perm:[1,0,3,2] row_mask:0xf bank_mask:0xf
s_nop 1
v_add_f32_dpp v48, v48, v48 quad_perm:[2,3,0,1] row_mask:0xf bank_mask:0xf
s_nop 1
v_add_f32_dpp v48, v48, v48 row_half_mirror row_mask:0xf bank_mask:0xf
s_nop 1
v_add_f32_dpp v48, v48, v48 row_ror:8 row_mask:0xf bank_mask:0xf
s_nop 1
v_add_f32_dpp v48, v48, v48 row_bcast:15 row_mask:0xa bank_mask:0xf
s_nop 1
v_add_f32_dpp v48, v48, v48 row_bcast:31 row_mask:0xc bank_mask:0xf
s_nop 0
v_readlane_b32 s84, v48, 63
v_mov_b32 v50, 986500301
s_nop 0
v_mul_f32 v50, s84, v50
v_cvt_pk_bf16_f32 v49, v49, v49
v_lshlrev_b32 v49, 16, v49
v_cvt_pk_bf16_f32 v50, v50, v50
v_lshlrev_b32 v50, 16, v50
v_add_f32 v50, 0x3727c5ac, v50
v_cvt_pk_bf16_f32 v50, v50, v50
v_lshlrev_b32 v50, 16, v50
v_sqrt_f32 v50, v50
s_nop 0
v_cvt_pk_bf16_f32 v50, v50, v50
v_lshlrev_b32 v50, 16, v50
v_lshlrev_b32 v32, 16, v20
v_and_b32 v33, 0xffff0000, v20
v_sub_f32 v32, v32, v49
v_cvt_pk_bf16_f32 v32, v32, v32
v_lshlrev_b32 v32, 16, v32
v_rcp_f32 v60, v50
s_nop 0
v_mul_f32 v52, v32, v60
v_fma_f32 v61, -v52, v50, v32
v_fma_f32 v52, v61, v60, v52
v_cvt_pk_bf16_f32 v52, v52, v52
v_lshlrev_b32 v52, 16, v52
v_sub_f32 v33, v33, v49
v_cvt_pk_bf16_f32 v33, v33, v33
v_lshlrev_b32 v33, 16, v33
v_rcp_f32 v60, v50
s_nop 0
v_mul_f32 v53, v33, v60
v_fma_f32 v61, -v53, v50, v33
v_fma_f32 v53, v61, v60, v53
v_cvt_pk_bf16_f32 v53, v53, v53
v_lshlrev_b32 v53, 16, v53
s_mul_i32 s89, s4, 640
s_add_u32 s89, s89, 360448
v_add_u32 v40, 0, v3
v_add_u32 v41, 5120, v3
v_add_u32 v42, 30720, v3
v_add_u32 v43, 35840, v3
v_add_u32 v44, 61440, v3
v_add_u32 v45, 66560, v3
v_add_u32 v46, 92160, v3
v_add_u32 v47, 97280, v3
s_mov_b32 exec_hi, 0xff
s_mov_b64 s[40:41], exec
s_mov_b32 s90, 65536
buffer_load_dwordx4 v[100:103], v40, s[52:55], s89 offen sc1
buffer_load_dwordx4 v[104:107], v41, s[52:55], s89 offen sc1
buffer_load_dwordx4 v[108:111], v42, s[52:55], s89 offen sc1
buffer_load_dwordx4 v[112:115], v43, s[52:55], s89 offen sc1
buffer_load_dwordx4 v[116:119], v44, s[52:55], s89 offen sc1
buffer_load_dwordx4 v[120:123], v45, s[52:55], s89 offen sc1
buffer_load_dwordx4 v[124:127], v46, s[52:55], s89 offen sc1
buffer_load_dwordx4 v[128:131], v47, s[52:55], s89 offen sc1
s_waitcnt vmcnt(8)
v_mov_b32 v62, 0
v_mov_b32 v63, 1
s_mov_b64 s[100:101], exec
s_mov_b64 exec, 1
ds_add_u32 v62, v63 offset:4
s_mov_b64 exec, -1
L_syncq_3:
ds_read_b32 v63, v62 offset:4
s_waitcnt lgkmcnt(0)
v_readfirstlane_b32 s84, v63
s_nop 1
s_cmp_ge_u32 s84, 4
s_cbranch_scc1 L_syncq_3_d
s_sleep 1
s_branch L_syncq_3
L_syncq_3_d:
v_lshlrev_b32 v34, 2, v28
v_add_u32 v34, v34, v30
v_mul_u32_u24 v34, 384, v34
v_add_u32 v34, v34, v31
s_mul_i32 s88, s91, 96
s_add_u32 s88, s88, 12288
v_add_u32 v34, s88, v34
ds_read_b64_tr_b16 v[68:69], v34 offset:0
ds_read_b64_tr_b16 v[70:71], v34 offset:6144
ds_read_b64_tr_b16 v[72:73], v34 offset:12288
ds_read_b64_tr_b16 v[74:75], v34 offset:18432
ds_read_b64_tr_b16 v[76:77], v34 offset:24576
ds_read_b64_tr_b16 v[78:79], v34 offset:32
ds_read_b64_tr_b16 v[80:81], v34 offset:6176
ds_read_b64_tr_b16 v[82:83], v34 offset:12320
ds_read_b64_tr_b16 v[84:85], v34 offset:18464
ds_read_b64_tr_b16 v[86:87], v34 offset:24608
ds_read_b64_tr_b16 v[88:89], v34 offset:64
ds_read_b64_tr_b16 v[90:91], v34 offset:6208
ds_read_b64_tr_b16 v[92:93], v34 offset:12352
ds_read_b64_tr_b16 v[94:95], v34 offset:18496
ds_read_b64_tr_b16 v[96:97], v34 offset:24640
s_mov_b64 exec, s[100:101]
L_tpoll_1:
s_waitcnt vmcnt(0)
v_xor_b32 v132, s42, v101
v_xor_b32 v141, s42, v103
v_or_b32 v132, v132, v141
v_xor_b32 v133, s42, v105
v_xor_b32 v141, s42, v107
v_or_b32 v133, v133, v141
v_xor_b32 v134, s42, v109
v_xor_b32 v141, s42, v111
v_or_b32 v134, v134, v141
v_xor_b32 v135, s42, v113
v_xor_b32 v141, s42, v115
v_or_b32 v135, v135, v141
v_xor_b32 v136, s42, v117
v_xor_b32 v141, s42, v119
v_or_b32 v136, v136, v141
v_xor_b32 v137, s42, v121
v_xor_b32 v141, s42, v123
v_or_b32 v137, v137, v141
v_xor_b32 v138, s42, v125
v_xor_b32 v141, s42, v127
v_or_b32 v138, v138, v141
v_xor_b32 v139, s42, v129
v_xor_b32 v141, s42, v131
v_or_b32 v139, v139, v141
v_or3_b32 v140, v132, v133, v134
v_or3_b32 v140, v140, v135, v136
v_or3_b32 v140, v140, v137, v138
v_or_b32 v140, v140, v139
v_cmp_ne_u32 vcc, 0, v140
s_cbranch_vccz L_tpolld_2
s_sub_u32 s90, s90, 1
s_cbranch_scc1 L_tpolld_2
s_sleep 8
v_cmp_ne_u32 s[16:17], 0, v132
v_cmp_ne_u32 s[18:19], 0, v133
v_cmp_ne_u32 s[20:21], 0, v134
v_cmp_ne_u32 s[22:23], 0, v135
v_cmp_ne_u32 s[24:25], 0, v136
v_cmp_ne_u32 s[26:27], 0, v137
v_cmp_ne_u32 s[28:29], 0, v138
v_cmp_ne_u32 s[30:31], 0, v139
s_mov_b64 exec, s[16:17]
buffer_load_dwordx4 v[100:103], v40, s[52:55], s89 offen sc1
s_mov_b64 exec, s[18:19]
buffer_load_dwordx4 v[104:107], v41, s[52:55], s89 offen sc1
s_mov_b64 exec, s[20:21]
buffer_load_dwordx4 v[108:111], v42, s[52:55], s89 offen sc1
s_mov_b64 exec, s[22:23]
buffer_load_dwordx4 v[112:115], v43, s[52:55], s89 offen sc1
s_mov_b64 exec, s[24:25]
buffer_load_dwordx4 v[116:119], v44, s[52:55], s89 offen sc1
s_mov_b64 exec, s[26:27]
buffer_load_dwordx4 v[120:123], v45, s[52:55], s89 offen sc1
s_mov_b64 exec, s[28:29]
buffer_load_dwordx4 v[124:127], v46, s[52:55], s89 offen sc1
s_mov_b64 exec, s[30:31]
buffer_load_dwordx4 v[128:131], v47, s[52:55], s89 offen sc1
s_mov_b64 exec, s[40:41]
s_branch L_tpoll_1
L_tpolld_2:
v_add_f32 v100, v100, v108
v_add_f32 v100, v100, v116
v_add_f32 v100, v100, v124
v_cvt_pk_bf16_f32 v100, v100, v100
v_lshlrev_b32 v100, 16, v100
v_add_f32 v104, v104, v112
v_add_f32 v104, v104, v120
v_add_f32 v104, v104, v128
v_cvt_pk_bf16_f32 v104, v104, v104
v_lshlrev_b32 v104, 16, v104
v_add_f32 v104, 1.0, v104
v_cvt_pk_bf16_f32 v104, v104, v104
v_lshlrev_b32 v104, 16, v104
v_mul_f32 v52, v52, v104
v_cvt_pk_bf16_f32 v52, v52, v52
v_lshlrev_b32 v52, 16, v52
v_add_f32 v52, v52, v100
v_add_f32 v102, v102, v110
v_add_f32 v102, v102, v118
v_add_f32 v102, v102, v126
v_cvt_pk_bf16_f32 v102, v102, v102
v_lshlrev_b32 v102, 16, v102
v_add_f32 v106, v106, v114
v_add_f32 v106, v106, v122
v_add_f32 v106, v106, v130
v_cvt_pk_bf16_f32 v106, v106, v106
v_lshlrev_b32 v106, 16, v106
v_add_f32 v106, 1.0, v106
v_cvt_pk_bf16_f32 v106, v106, v106
v_lshlrev_b32 v106, 16, v106
v_mul_f32 v53, v53, v106
v_cvt_pk_bf16_f32 v53, v53, v53
v_lshlrev_b32 v53, 16, v53
v_add_f32 v53, v53, v102
v_cvt_pk_bf16_f32 v52, v52, v53
ds_write_b32 v4, v52 offset:1024
s_waitcnt lgkmcnt(0)
v_mov_b32 v35, 0
v_mov_b32 v36, 1
s_mov_b64 exec, 1
ds_write_b32 v35, v36 offset:24
s_mov_b64 exec, -1
s_branch L_h_waith
L_h_wq:
s_waitcnt vmcnt(0)
v_mov_b32 v62, 0
v_mov_b32 v63, 1
s_mov_b64 s[100:101], exec
s_mov_b64 exec, 1
ds_add_u32 v62, v63 offset:4
s_mov_b64 exec, -1
L_syncq_4:
ds_read_b32 v63, v62 offset:4
s_waitcnt lgkmcnt(0)
v_readfirstlane_b32 s84, v63
s_nop 1
s_cmp_ge_u32 s84, 4
s_cbranch_scc1 L_syncq_4_d
s_sleep 1
s_branch L_syncq_4
L_syncq_4_d:
v_lshlrev_b32 v34, 2, v28
v_add_u32 v34, v34, v30
v_mul_u32_u24 v34, 384, v34
v_add_u32 v34, v34, v31
s_mul_i32 s88, s91, 96
s_add_u32 s88, s88, 12288
v_add_u32 v34, s88, v34
ds_read_b64_tr_b16 v[68:69], v34 offset:0
ds_read_b64_tr_b16 v[70:71], v34 offset:6144
ds_read_b64_tr_b16 v[72:73], v34 offset:12288
ds_read_b64_tr_b16 v[74:75], v34 offset:18432
ds_read_b64_tr_b16 v[76:77], v34 offset:24576
ds_read_b64_tr_b16 v[78:79], v34 offset:32
ds_read_b64_tr_b16 v[80:81], v34 offset:6176
ds_read_b64_tr_b16 v[82:83], v34 offset:12320
ds_read_b64_tr_b16 v[84:85], v34 offset:18464
ds_read_b64_tr_b16 v[86:87], v34 offset:24608
ds_read_b64_tr_b16 v[88:89], v34 offset:64
ds_read_b64_tr_b16 v[90:91], v34 offset:6208
ds_read_b64_tr_b16 v[92:93], v34 offset:12352
ds_read_b64_tr_b16 v[94:95], v34 offset:18496
ds_read_b64_tr_b16 v[96:97], v34 offset:24640
s_mov_b64 exec, s[100:101]
s_cmp_lg_u32 s91, 1
s_cbranch_scc1 L_h_waith
s_cmp_lt_u32 s2, 240
s_cbranch_scc1 L_h_waith
s_sub_u32 s84, s2, 240
s_and_b32 s88, s84, 1
s_lshl_b32 s88, s88, 7
s_lshr_b32 s89, s84, 1
s_lshl_b32 s89, s89, 2
s_add_u32 s88, s88, s89
v_mov_b32 v36, 1
v_mov_b32 v35, s88
s_mov_b64 exec, 1
buffer_store_dword v36, v35, s[76:79], 0 offen sc1
s_mov_b64 exec, -1
L_h_waith:
v_mov_b32 v35, 0
L_h_hspin:
ds_read_b32 v36, v35 offset:24
s_waitcnt lgkmcnt(0)
v_readfirstlane_b32 s84, v36
s_nop 1
s_cmp_ge_u32 s84, 1
s_cbranch_scc1 L_h_hspin_d
s_sleep 1
s_branch L_h_hspin
L_h_hspin_d:
v_lshlrev_b32 v34, 3, v28
ds_read_b64 v[56:57], v34 offset:1024
ds_read_b64 v[58:59], v34 offset:1056
ds_read_b64 v[60:61], v34 offset:1088
ds_read_b64 v[62:63], v34 offset:1120
ds_read_b64 v[64:65], v34 offset:1152
s_waitcnt lgkmcnt(0)
v_mfma_f32_16x16x16_bf16 v[100:103], v[56:57], v[68:69], 0
v_mfma_f32_16x16x16_bf16 v[104:107], v[56:57], v[78:79], 0
v_mfma_f32_16x16x16_bf16 v[108:111], v[56:57], v[88:89], 0
v_mfma_f32_16x16x16_bf16 v[100:103], v[58:59], v[70:71], v[100:103]
v_mfma_f32_16x16x16_bf16 v[104:107], v[58:59], v[80:81], v[104:107]
v_mfma_f32_16x16x16_bf16 v[108:111], v[58:59], v[90:91], v[108:111]
v_mfma_f32_16x16x16_bf16 v[100:103], v[60:61], v[72:73], v[100:103]
v_mfma_f32_16x16x16_bf16 v[104:107], v[60:61], v[82:83], v[104:107]
v_mfma_f32_16x16x16_bf16 v[108:111], v[60:61], v[92:93], v[108:111]
v_mfma_f32_16x16x16_bf16 v[100:103], v[62:63], v[74:75], v[100:103]
v_mfma_f32_16x16x16_bf16 v[104:107], v[62:63], v[84:85], v[104:107]
v_mfma_f32_16x16x16_bf16 v[108:111], v[62:63], v[94:95], v[108:111]
v_mfma_f32_16x16x16_bf16 v[100:103], v[64:65], v[76:77], v[100:103]
v_mfma_f32_16x16x16_bf16 v[104:107], v[64:65], v[86:87], v[104:107]
v_mfma_f32_16x16x16_bf16 v[108:111], v[64:65], v[96:97], v[108:111]
v_cmp_eq_u32 vcc, 1, v28
s_nop 5
v_cndmask_b32 v34, v100, v104, vcc
v_cmp_eq_u32 vcc, 2, v28
s_nop 1
v_cndmask_b32 v34, v34, v108, vcc
v_mov_b32 v35, s42
s_mul_i32 s84, s4, 49152
s_mul_i32 s88, s5, 1536
s_add_u32 s84, s84, s88
s_mul_i32 s88, s91, 384
s_add_u32 s84, s84, s88
s_add_u32 s84, s84, 483328
s_mov_b32 exec_hi, 0xffff
buffer_store_dwordx2 v[34:35], v2, s[52:55], s84 offen sc1
s_mov_b64 exec, -1
s_cmp_ge_u32 s91, 3
s_cbranch_scc1 L_h_flg
s_mul_i32 s84, s5, 1536
s_lshl_b32 s88, s91, 9
s_add_u32 s84, s84, s88
s_add_u32 s84, s84, 483328
v_add_u32 v36, 0, v2
v_add_u32 v37, 49152, v2
v_add_u32 v38, 98304, v2
v_add_u32 v39, 147456, v2
v_add_u32 v40, 196608, v2
v_add_u32 v41, 245760, v2
v_add_u32 v42, 294912, v2
v_add_u32 v43, 344064, v2
s_mov_b32 s90, 65536
buffer_load_dwordx2 v[100:101], v36, s[52:55], s84 offen sc1
buffer_load_dwordx2 v[102:103], v37, s[52:55], s84 offen sc1
buffer_load_dwordx2 v[104:105], v38, s[52:55], s84 offen sc1
buffer_load_dwordx2 v[106:107], v39, s[52:55], s84 offen sc1
buffer_load_dwordx2 v[108:109], v40, s[52:55], s84 offen sc1
buffer_load_dwordx2 v[110:111], v41, s[52:55], s84 offen sc1
buffer_load_dwordx2 v[112:113], v42, s[52:55], s84 offen sc1
buffer_load_dwordx2 v[114:115], v43, s[52:55], s84 offen sc1
L_tpoll_5:
s_waitcnt vmcnt(0)
v_xor_b32 v132, s42, v101
v_xor_b32 v133, s42, v103
v_xor_b32 v134, s42, v105
v_xor_b32 v135, s42, v107
v_xor_b32 v136, s42, v109
v_xor_b32 v137, s42, v111
v_xor_b32 v138, s42, v113
v_xor_b32 v139, s42, v115
v_or3_b32 v140, v132, v133, v134
v_or3_b32 v140, v140, v135, v136
v_or3_b32 v140, v140, v137, v138
v_or_b32 v140, v140, v139
v_cmp_ne_u32 vcc, 0, v140
s_cbranch_vccz L_tpolld_6
s_sub_u32 s90, s90, 1
s_cbranch_scc1 L_tpolld_6
s_sleep 4
v_cmp_ne_u32 s[16:17], 0, v132
v_cmp_ne_u32 s[18:19], 0, v133
v_cmp_ne_u32 s[20:21], 0, v134
v_cmp_ne_u32 s[22:23], 0, v135
v_cmp_ne_u32 s[24:25], 0, v136
v_cmp_ne_u32 s[26:27], 0, v137
v_cmp_ne_u32 s[28:29], 0, v138
v_cmp_ne_u32 s[30:31], 0, v139
s_mov_b64 exec, s[16:17]
buffer_load_dwordx2 v[100:101], v36, s[52:55], s84 offen sc1
s_mov_b64 exec, s[18:19]
buffer_load_dwordx2 v[102:103], v37, s[52:55], s84 offen sc1
s_mov_b64 exec, s[20:21]
buffer_load_dwordx2 v[104:105], v38, s[52:55], s84 offen sc1
s_mov_b64 exec, s[22:23]
buffer_load_dwordx2 v[106:107], v39, s[52:55], s84 offen sc1
s_mov_b64 exec, s[24:25]
buffer_load_dwordx2 v[108:109], v40, s[52:55], s84 offen sc1
s_mov_b64 exec, s[26:27]
buffer_load_dwordx2 v[110:111], v41, s[52:55], s84 offen sc1
s_mov_b64 exec, s[28:29]
buffer_load_dwordx2 v[112:113], v42, s[52:55], s84 offen sc1
s_mov_b64 exec, s[30:31]
buffer_load_dwordx2 v[114:115], v43, s[52:55], s84 offen sc1
s_mov_b64 exec, -1
s_branch L_tpoll_5
L_tpolld_6:
v_add_f32 v100, v100, v102
v_add_f32 v100, v100, v104
v_add_f32 v100, v100, v106
v_add_f32 v100, v100, v108
v_add_f32 v100, v100, v110
v_add_f32 v100, v100, v112
v_add_f32 v100, v100, v114
v_cvt_pk_bf16_f32 v100, v100, v100
s_lshl_b32 s84, s91, 7
v_lshlrev_b32 v34, 1, v1
v_add_u32 v34, s84, v34
ds_write_b16 v34, v100 offset:256
s_waitcnt lgkmcnt(0)
v_mov_b32 v35, 0
v_mov_b32 v36, 1
s_mov_b64 exec, 1
ds_add_u32 v35, v36 offset:8
s_mov_b64 exec, -1
s_cmp_eq_u32 s91, 0
s_cbranch_scc1 L_h_ml
s_branch L_h_b1
L_h_flg:
s_mov_b32 s90, 65536
s_mov_b32 exec_lo, 255
s_mov_b32 exec_hi, 255
L_h_flags:
buffer_load_dword v35, v4, s[76:79], 0 offen sc1
s_waitcnt vmcnt(0)
v_cmp_ne_u32 vcc, 1, v35
s_cbranch_vccz L_h_flagsd
s_sub_u32 s90, s90, 1
s_cbranch_scc1 L_h_flagsd
s_sleep 8
s_branch L_h_flags
L_h_flagsd:
v_mov_b32 v35, 0
v_mov_b32 v36, 1
s_mov_b64 exec, 1
ds_write_b32 v35, v36 offset:56
s_mov_b64 exec, -1
s_cmp_eq_u32 s7, 3
s_cbranch_scc0 L_nof_7
s_sub_u32 s84, s6, 236
s_lshl_b32 s84, s84, 10
v_lshlrev_b32 v2, 3, v1
s_add_u32 s88, s84, 370688
v_add_u32 v8, 0, v2
v_add_u32 v9, 30720, v2
v_add_u32 v10, 61440, v2
v_add_u32 v11, 92160, v2
v_add_u32 v12, 512, v2
v_add_u32 v13, 31232, v2
v_add_u32 v14, 61952, v2
v_add_u32 v15, 92672, v2
s_mov_b32 s90, 65536
buffer_load_dwordx2 v[16:17], v8, s[52:55], s88 offen sc1
buffer_load_dwordx2 v[18:19], v9, s[52:55], s88 offen sc1
buffer_load_dwordx2 v[20:21], v10, s[52:55], s88 offen sc1
buffer_load_dwordx2 v[22:23], v11, s[52:55], s88 offen sc1
buffer_load_dwordx2 v[24:25], v12, s[52:55], s88 offen sc1
buffer_load_dwordx2 v[26:27], v13, s[52:55], s88 offen sc1
buffer_load_dwordx2 v[28:29], v14, s[52:55], s88 offen sc1
buffer_load_dwordx2 v[30:31], v15, s[52:55], s88 offen sc1
L_tpoll_8:
s_waitcnt vmcnt(0)
v_xor_b32 v48, s42, v17
v_xor_b32 v49, s42, v19
v_xor_b32 v50, s42, v21
v_xor_b32 v51, s42, v23
v_xor_b32 v52, s42, v25
v_xor_b32 v53, s42, v27
v_xor_b32 v54, s42, v29
v_xor_b32 v55, s42, v31
v_or3_b32 v56, v48, v49, v50
v_or3_b32 v56, v56, v51, v52
v_or3_b32 v56, v56, v53, v54
v_or_b32 v56, v56, v55
v_cmp_ne_u32 vcc, 0, v56
s_cbranch_vccz L_tpolld_9
s_sub_u32 s90, s90, 1
s_cbranch_scc1 L_tpolld_9
s_sleep 8
v_cmp_ne_u32 s[16:17], 0, v48
v_cmp_ne_u32 s[18:19], 0, v49
v_cmp_ne_u32 s[20:21], 0, v50
v_cmp_ne_u32 s[22:23], 0, v51
v_cmp_ne_u32 s[24:25], 0, v52
v_cmp_ne_u32 s[26:27], 0, v53
v_cmp_ne_u32 s[28:29], 0, v54
v_cmp_ne_u32 s[30:31], 0, v55
s_mov_b64 exec, s[16:17]
buffer_load_dwordx2 v[16:17], v8, s[52:55], s88 offen sc1
s_mov_b64 exec, s[18:19]
buffer_load_dwordx2 v[18:19], v9, s[52:55], s88 offen sc1
s_mov_b64 exec, s[20:21]
buffer_load_dwordx2 v[20:21], v10, s[52:55], s88 offen sc1
s_mov_b64 exec, s[22:23]
buffer_load_dwordx2 v[22:23], v11, s[52:55], s88 offen sc1
s_mov_b64 exec, s[24:25]
buffer_load_dwordx2 v[24:25], v12, s[52:55], s88 offen sc1
s_mov_b64 exec, s[26:27]
buffer_load_dwordx2 v[26:27], v13, s[52:55], s88 offen sc1
s_mov_b64 exec, s[28:29]
buffer_load_dwordx2 v[28:29], v14, s[52:55], s88 offen sc1
s_mov_b64 exec, s[30:31]
buffer_load_dwordx2 v[30:31], v15, s[52:55], s88 offen sc1
s_mov_b64 exec, -1
s_branch L_tpoll_8
L_tpolld_9:
s_lshr_b32 s89, s84, 3
v_add_f32 v40, v16, v18
v_add_f32 v40, v40, v20
v_add_f32 v40, v40, v22
v_cvt_pk_bf16_f32 v40, v40, v40
v_lshlrev_b32 v40, 16, v40
v_add_f32 v36, 1.0, v40
v_cvt_pk_bf16_f32 v36, v36, v36
v_lshlrev_b32 v36, 16, v36
v_add_u32 v37, 0, v1
v_add_u32 v37, s89, v37
v_subrev_u32 v37, 1280, v37
v_cmp_gt_u32 vcc, 640, v37
s_nop 1
v_cndmask_b32 v40, v40, v36, vcc
v_mov_b32 v41, s42
v_add_f32 v42, v24, v26
v_add_f32 v42, v42, v28
v_add_f32 v42, v42, v30
v_cvt_pk_bf16_f32 v42, v42, v42
v_lshlrev_b32 v42, 16, v42
v_add_f32 v36, 1.0, v42
v_cvt_pk_bf16_f32 v36, v36, v36
v_lshlrev_b32 v36, 16, v36
v_add_u32 v37, 64, v1
v_add_u32 v37, s89, v37
v_subrev_u32 v37, 1280, v37
v_cmp_gt_u32 vcc, 640, v37
s_nop 1
v_cndmask_b32 v42, v42, v36, vcc
v_mov_b32 v43, s42
s_add_u32 s88, s84, 876544
buffer_store_dwordx2 v[40:41], v2, s[52:55], s88 offen offset:0 sc1
buffer_store_dwordx2 v[42:43], v2, s[52:55], s88 offen offset:512 sc1
L_nof_7:
L_h_b1:
s_branch L_h_b4
L_h_ml:
v_and_b32 v4, 7, v1
v_lshlrev_b32 v4, 2, v4
v_mov_b32 v35, 0
L_h_frspin:
ds_read_b32 v36, v35 offset:56
s_waitcnt lgkmcnt(0)
v_readfirstlane_b32 s84, v36
s_nop 1
s_cmp_ge_u32 s84, 1
s_cbranch_scc1 L_h_frspin_d
s_sleep 1
s_branch L_h_frspin
L_h_frspin_d:
L_h_mlspin:
ds_read_b32 v36, v35 offset:12
s_waitcnt lgkmcnt(0)
v_readfirstlane_b32 s84, v36
s_nop 1
s_cmp_ge_u32 s84, 8
s_cbranch_scc1 L_h_mlspin_d
s_sleep 1
s_branch L_h_mlspin
L_h_mlspin_d:
ds_read_b32 v8, v4 offset:896
ds_read_b32 v9, v4 offset:928
s_lshl_b32 s84, s5, 6
s_add_u32 s84, s84, 55296
s_lshl_b32 s88, s4, 3
s_add_u32 s88, s88, s84
s_waitcnt lgkmcnt(0)
v_max_f32_dpp v8, v8, v8 quad_perm:[1,0,3,2] row_mask:0xf bank_mask:0xf
v_add_f32_dpp v9, v9, v9 quad_perm:[1,0,3,2] row_mask:0xf bank_mask:0xf
s_nop 0
v_max_f32_dpp v8, v8, v8 quad_perm:[2,3,0,1] row_mask:0xf bank_mask:0xf
v_add_f32_dpp v9, v9, v9 quad_perm:[2,3,0,1] row_mask:0xf bank_mask:0xf
s_nop 0
v_max_f32_dpp v8, v8, v8 row_half_mirror row_mask:0xf bank_mask:0xf
v_add_f32_dpp v9, v9, v9 row_half_mirror row_mask:0xf bank_mask:0xf
v_min_u32 v8, -2, v8
v_min_u32 v9, -2, v9
s_mov_b64 exec, 1
buffer_store_dwordx2 v[8:9], v35, s[52:55], s88 offen sc1
s_mov_b64 exec, -1
L_h_b4:
s_cmp_eq_u32 s3, 8
s_cbranch_scc1 L_h_prepd2
v_mov_b32 v35, 0
L_h_p2spin:
ds_read_b32 v36, v35 offset:12
s_waitcnt lgkmcnt(0)
v_readfirstlane_b32 s84, v36
s_nop 1
s_cmp_ge_u32 s84, 8
s_cbranch_scc1 L_h_p2spin_d
s_sleep 1
s_branch L_h_p2spin
L_h_p2spin_d:
s_cmp_eq_u32 s7, 1
s_cbranch_scc1 L_h_prepG
s_cmp_eq_u32 s7, 2
s_cbranch_scc0 L_h_prepd2
s_cmp_eq_u32 s3, 9
s_cbranch_scc0 L_h_prepd2
s_lshl_b32 s84, s10, 8
s_add_u32 s84, s84, 876544
v_cmp_le_u32 vcc, 16, v1
v_mov_b32 v5, 0
v_mov_b32 v6, 15104
v_cndmask_b32 v5, v5, v6, vcc
v_lshlrev_b32 v4, 4, v1
v_add_u32 v4, v4, v5
v_mov_b32 v5, 4096
v_mov_b32 v6, 6528
v_cndmask_b32 v5, v5, v6, vcc
v_lshlrev_b32 v3, 3, v1
v_add_u32 v5, v5, v3
s_mov_b32 exec_hi, 0
s_mov_b64 s[40:41], exec
s_mov_b32 s90, 65536
buffer_load_dwordx4 v[12:15], v4, s[52:55], s84 offen sc1
L_tpoll_10:
s_waitcnt vmcnt(0)
v_xor_b32 v48, s42, v13
v_xor_b32 v50, s42, v15
v_or_b32 v48, v48, v50
v_mov_b32 v49, v48
v_cmp_ne_u32 vcc, 0, v49
s_cbranch_vccz L_tpolld_11
s_sub_u32 s90, s90, 1
s_cbranch_scc1 L_tpolld_11
s_sleep 8
v_cmp_ne_u32 s[16:17], 0, v48
s_nop 1
s_mov_b64 exec, s[16:17]
buffer_load_dwordx4 v[12:15], v4, s[52:55], s84 offen sc1
s_mov_b64 exec, s[40:41]
s_branch L_tpoll_10
L_tpolld_11:
ds_write2_b32 v5, v12, v14 offset0:0 offset1:1
s_mov_b64 exec, -1
s_branch L_h_prepd2
L_h_prepG:
s_sub_u32 s84, s91, 1
s_lshl_b32 s84, s84, 6
v_add_u32 v2, s84, v1
s_mul_i32 s88, s12, 320
s_add_u32 s89, s88, 320
v_add_u32 v4, 0, v2
v_lshlrev_b32 v8, 1, v4
v_lshlrev_b32 v8, 3, v8
v_lshlrev_b32 v4, 3, v4
v_add_u32 v5, 192, v2
v_lshlrev_b32 v9, 1, v5
v_mov_b32 v3, s88
v_cmp_le_u32 vcc, 320, v5
s_nop 1
v_cndmask_b32 v3, 0, v3, vcc
v_mov_b32 v12, s89
v_cmp_le_u32 vcc, 480, v5
s_nop 1
v_cndmask_b32 v3, v3, v12, vcc
v_add_u32 v9, v9, v3
v_lshlrev_b32 v9, 3, v9
v_lshlrev_b32 v5, 3, v5
v_add_u32 v6, 384, v2
v_lshlrev_b32 v10, 1, v6
v_mov_b32 v3, s88
v_cmp_le_u32 vcc, 320, v6
s_nop 1
v_cndmask_b32 v3, 0, v3, vcc
v_mov_b32 v12, s89
v_cmp_le_u32 vcc, 480, v6
s_nop 1
v_cndmask_b32 v3, v3, v12, vcc
v_add_u32 v10, v10, v3
v_lshlrev_b32 v10, 3, v10
v_lshlrev_b32 v6, 3, v6
v_add_u32 v7, 576, v2
v_min_u32 v7, 639, v7
v_lshlrev_b32 v11, 1, v7
v_mov_b32 v3, s88
v_cmp_le_u32 vcc, 320, v7
s_nop 1
v_cndmask_b32 v3, 0, v3, vcc
v_mov_b32 v12, s89
v_cmp_le_u32 vcc, 480, v7
s_nop 1
v_cndmask_b32 v3, v3, v12, vcc
v_add_u32 v11, v11, v3
v_lshlrev_b32 v11, 3, v11
v_lshlrev_b32 v7, 3, v7
s_mov_b32 s84, 876544
s_mov_b32 s90, 65536
buffer_load_dwordx4 v[16:19], v8, s[52:55], s84 offen sc1
buffer_load_dwordx4 v[20:23], v9, s[52:55], s84 offen sc1
buffer_load_dwordx4 v[24:27], v10, s[52:55], s84 offen sc1
buffer_load_dwordx4 v[28:31], v11, s[52:55], s84 offen sc1
L_tpoll_12:
s_waitcnt vmcnt(0)
v_xor_b32 v48, s42, v17
v_xor_b32 v53, s42, v19
v_or_b32 v48, v48, v53
v_xor_b32 v49, s42, v21
v_xor_b32 v53, s42, v23
v_or_b32 v49, v49, v53
v_xor_b32 v50, s42, v25
v_xor_b32 v53, s42, v27
v_or_b32 v50, v50, v53
v_xor_b32 v51, s42, v29
v_xor_b32 v53, s42, v31
v_or_b32 v51, v51, v53
v_or3_b32 v52, v48, v49, v50
v_or_b32 v52, v52, v51
v_cmp_ne_u32 vcc, 0, v52
s_cbranch_vccz L_tpolld_13
s_sub_u32 s90, s90, 1
s_cbranch_scc1 L_tpolld_13
s_sleep 8
v_cmp_ne_u32 s[16:17], 0, v48
v_cmp_ne_u32 s[18:19], 0, v49
v_cmp_ne_u32 s[20:21], 0, v50
v_cmp_ne_u32 s[22:23], 0, v51
s_mov_b64 exec, s[16:17]
buffer_load_dwordx4 v[16:19], v8, s[52:55], s84 offen sc1
s_mov_b64 exec, s[18:19]
buffer_load_dwordx4 v[20:23], v9, s[52:55], s84 offen sc1
s_mov_b64 exec, s[20:21]
buffer_load_dwordx4 v[24:27], v10, s[52:55], s84 offen sc1
s_mov_b64 exec, s[22:23]
buffer_load_dwordx4 v[28:31], v11, s[52:55], s84 offen sc1
s_mov_b64 exec, -1
s_branch L_tpoll_12
L_tpolld_13:
v_add_u32 v4, 4096, v4
ds_write2_b32 v4, v16, v18 offset0:0 offset1:1
v_add_u32 v5, 4096, v5
ds_write2_b32 v5, v20, v22 offset0:0 offset1:1
v_add_u32 v6, 4096, v6
ds_write2_b32 v6, v24, v26 offset0:0 offset1:1
v_add_u32 v7, 4096, v7
ds_write2_b32 v7, v28, v30 offset0:0 offset1:1
L_h_prepd2:
s_waitcnt lgkmcnt(0)
s_cmp_eq_u32 s13, 0
s_cbranch_scc1 L_h_dmad
v_lshrrev_b32 v5, s86, v1
s_lshl_b32 s84, 1, s86
s_sub_u32 s84, s84, 1
v_and_b32 v6, s84, v1
v_lshlrev_b32 v6, 4, v6
v_mul_lo_u32 v5, v5, s87
v_add_u32 v5, v5, v6
s_lshl_b32 s13, s13, 1
s_mul_i32 s84, s91, s13
s_mul_i32 s87, s84, s14
s_lshl_b32 s86, s84, 10
s_add_u32 s86, s86, 65536
v_mov_b32 v6, 0
s_mov_b32 s88, 28
s_mov_b32 s89, 8
s_cmp_eq_u32 s7, 1
s_cselect_b32 s88, 44, s88
s_cselect_b32 s89, 8, s89
s_cmp_eq_u32 s7, 2
s_cselect_b32 s88, 60, s88
s_cselect_b32 s89, 3, s89
v_mov_b32 v6, s88
L_h_vspin:
ds_read_b32 v7, v6
s_waitcnt lgkmcnt(0)
v_readfirstlane_b32 s84, v7
s_nop 1
s_cmp_ge_u32 s84, s89
s_cbranch_scc1 L_h_vspin_d
s_sleep 1
s_branch L_h_vspin
L_h_vspin_d:
L_dma:
s_mov_b32 m0, s86
s_nop 0
buffer_load_dwordx4 v5, s[56:59], s87 offen nt lds
s_add_u32 s86, s86, 1024
s_add_u32 s87, s87, s14
s_sub_u32 s13, s13, 1
s_cmp_lg_u32 s13, 0
s_cbranch_scc1 L_dma
L_h_dmad:
s_waitcnt vmcnt(0)
v_mov_b32 v6, 0
v_mov_b32 v7, 1
s_mov_b64 exec, 1
ds_add_u32 v6, v7 offset:32
s_mov_b64 exec, -1
L_tail:
s_setprio 2
v_lshrrev_b32 v28, 4, v1
v_and_b32 v29, 15, v1
v_lshrrev_b32 v30, 2, v29
v_and_b32 v31, 3, v29
v_lshlrev_b32 v31, 3, v31
v_lshlrev_b32 v27, 2, v1
s_lshl_b32 s85, s3, 8
s_add_u32 s85, s85, 18432
s_cmp_eq_u32 s7, 0
s_cbranch_scc1 L_tW
s_cmp_eq_u32 s7, 1
s_cbranch_scc1 L_tG
s_cmp_eq_u32 s7, 2
s_cbranch_scc1 L_tD
s_branch L_end
L_tW:
s_cmp_ge_u32 s3, 8
s_cbranch_scc1 L_end
s_lshl_b32 s88, s10, 3
s_add_u32 s88, s88, s3
s_mul_i32 s88, s88, 43691
s_lshr_b32 s88, s88, 17
s_lshl_b32 s88, s88, 6
s_add_u32 s88, s88, 55296
v_and_b32 v24, 7, v1
v_lshlrev_b32 v24, 3, v24
s_mov_b32 s90, 65536
buffer_load_dwordx2 v[16:17], v24, s[52:55], s88 offen sc1
L_poll_14:
s_waitcnt vmcnt(0)
v_max_u32 v124, v16, v17
v_mov_b32 v125, v124
v_cmp_eq_u32 vcc, -1, v125
s_cbranch_vccz L_polld_15
s_sub_u32 s90, s90, 1
s_cbranch_scc1 L_polld_15
s_sleep 2
s_mov_b64 exec, vcc
buffer_load_dwordx2 v[16:17], v24, s[52:55], s88 offen sc1
s_mov_b64 exec, -1
s_branch L_poll_14
L_polld_15:
v_mov_b32 v100, v16
s_nop 1
v_max_f32_dpp v100, v100, v100 quad_perm:[1,0,3,2] row_mask:0xf bank_mask:0xf
s_nop 1
v_max_f32_dpp v100, v100, v100 quad_perm:[2,3,0,1] row_mask:0xf bank_mask:0xf
s_nop 1
v_max_f32_dpp v100, v100, v100 row_half_mirror row_mask:0xf bank_mask:0xf
v_sub_f32 v101, v16, v100
v_mul_f32 v101, 0x3fb8aa3b, v101
v_exp_f32 v101, v101
s_nop 0
v_mul_f32 v102, v101, v17
s_nop 1
v_add_f32_dpp v102, v102, v102 quad_perm:[1,0,3,2] row_mask:0xf bank_mask:0xf
s_nop 1
v_add_f32_dpp v102, v102, v102 quad_perm:[2,3,0,1] row_mask:0xf bank_mask:0xf
s_nop 1
v_add_f32_dpp v102, v102, v102 row_half_mirror row_mask:0xf bank_mask:0xf
v_rcp_f32 v104, v102
s_nop 0
v_mul_f32 v103, v101, v104
v_fma_f32 v105, -v103, v102, v101
v_fma_f32 v103, v105, v104, v103
s_nop 0
v_readlane_b32 s16, v103, 0
v_readlane_b32 s17, v103, 1
v_readlane_b32 s18, v103, 2
v_readlane_b32 s19, v103, 3
v_readlane_b32 s20, v103, 4
v_readlane_b32 s21, v103, 5
v_readlane_b32 s22, v103, 6
v_readlane_b32 s23, v103, 7
v_mov_b32 v6, 0
L_tW_dspin:
ds_read_b32 v7, v6 offset:32
s_waitcnt lgkmcnt(0)
v_readfirstlane_b32 s84, v7
s_nop 1
s_cmp_ge_u32 s84, 4
s_cbranch_scc1 L_tW_dspin_d
s_sleep 1
s_branch L_tW_dspin
L_tW_dspin_d:
v_lshlrev_b32 v26, 3, v28
v_add_u32 v26, v26, v30
v_lshlrev_b32 v26, 7, v26
v_add_u32 v26, v26, v31
s_lshl_b32 s84, s3, 13
s_add_u32 s84, s84, 65536
v_add_u32 v26, s84, v26
ds_read_b64_tr_b16 v[32:33], v26 offset:0
ds_read_b64_tr_b16 v[34:35], v26 offset:512
ds_read_b64_tr_b16 v[36:37], v26 offset:32
ds_read_b64_tr_b16 v[38:39], v26 offset:544
ds_read_b64_tr_b16 v[40:41], v26 offset:64
ds_read_b64_tr_b16 v[42:43], v26 offset:576
ds_read_b64_tr_b16 v[44:45], v26 offset:96
ds_read_b64_tr_b16 v[46:47], v26 offset:608
ds_read_b64_tr_b16 v[48:49], v26 offset:4096
ds_read_b64_tr_b16 v[50:51], v26 offset:4608
ds_read_b64_tr_b16 v[52:53], v26 offset:4128
ds_read_b64_tr_b16 v[54:55], v26 offset:4640
ds_read_b64_tr_b16 v[56:57], v26 offset:4160
ds_read_b64_tr_b16 v[58:59], v26 offset:4672
ds_read_b64_tr_b16 v[60:61], v26 offset:4192
ds_read_b64_tr_b16 v[62:63], v26 offset:4704
s_lshl_b32 s84, s10, 11
s_lshl_b32 s88, s3, 8
s_add_u32 s84, s84, s88
s_add_u32 s84, s84, 71680
v_add_u32 v8, 0, v27
v_add_u32 v9, 24576, v27
v_add_u32 v10, 49152, v27
v_add_u32 v11, 73728, v27
v_add_u32 v12, 98304, v27
v_add_u32 v13, 122880, v27
v_add_u32 v14, 147456, v27
v_add_u32 v15, 172032, v27
s_mov_b32 s90, 65536
buffer_load_dword v16, v8, s[52:55], s84 offen sc1
buffer_load_dword v17, v9, s[52:55], s84 offen sc1
buffer_load_dword v18, v10, s[52:55], s84 offen sc1
buffer_load_dword v19, v11, s[52:55], s84 offen sc1
buffer_load_dword v20, v12, s[52:55], s84 offen sc1
buffer_load_dword v21, v13, s[52:55], s84 offen sc1
buffer_load_dword v22, v14, s[52:55], s84 offen sc1
buffer_load_dword v23, v15, s[52:55], s84 offen sc1
L_poll_16:
s_waitcnt vmcnt(0)
v_max3_u32 v124, v16, v17, v18
v_max3_u32 v124, v124, v19, v20
v_max3_u32 v124, v124, v21, v22
v_max_u32 v124, v124, v23
v_cmp_eq_u32 vcc, -1, v124
s_cbranch_vccz L_polld_17
s_sub_u32 s90, s90, 1
s_cbranch_scc1 L_polld_17
s_sleep 2
v_cmp_eq_u32 vcc, -1, v16
s_nop 1
s_mov_b64 exec, vcc
buffer_load_dword v16, v8, s[52:55], s84 offen sc1
s_mov_b64 exec, -1
v_cmp_eq_u32 vcc, -1, v17
s_nop 1
s_mov_b64 exec, vcc
buffer_load_dword v17, v9, s[52:55], s84 offen sc1
s_mov_b64 exec, -1
v_cmp_eq_u32 vcc, -1, v18
s_nop 1
s_mov_b64 exec, vcc
buffer_load_dword v18, v10, s[52:55], s84 offen sc1
s_mov_b64 exec, -1
v_cmp_eq_u32 vcc, -1, v19
s_nop 1
s_mov_b64 exec, vcc
buffer_load_dword v19, v11, s[52:55], s84 offen sc1
s_mov_b64 exec, -1
v_cmp_eq_u32 vcc, -1, v20
s_nop 1
s_mov_b64 exec, vcc
buffer_load_dword v20, v12, s[52:55], s84 offen sc1
s_mov_b64 exec, -1
v_cmp_eq_u32 vcc, -1, v21
s_nop 1
s_mov_b64 exec, vcc
buffer_load_dword v21, v13, s[52:55], s84 offen sc1
s_mov_b64 exec, -1
v_cmp_eq_u32 vcc, -1, v22
s_nop 1
s_mov_b64 exec, vcc
buffer_load_dword v22, v14, s[52:55], s84 offen sc1
s_mov_b64 exec, -1
v_cmp_eq_u32 vcc, -1, v23
s_nop 1
s_mov_b64 exec, vcc
buffer_load_dword v23, v15, s[52:55], s84 offen sc1
s_mov_b64 exec, -1
s_branch L_poll_16
L_polld_17:
v_mul_f32 v24, s16, v16
v_mul_f32 v25, s17, v17
v_fmac_f32 v24, s18, v18
v_fmac_f32 v25, s19, v19
v_fmac_f32 v24, s20, v20
v_fmac_f32 v25, s21, v21
v_fmac_f32 v24, s22, v22
v_fmac_f32 v25, s23, v23
v_add_f32 v24, v24, v25
v_cvt_pk_bf16_f32 v25, v24, v24
v_lshlrev_b32 v24, 1, v1
v_add_u32 v24, s85, v24
ds_write_b16 v24, v25
v_lshlrev_b32 v24, 4, v28
v_add_u32 v24, s85, v24
s_waitcnt lgkmcnt(0)
ds_read_b128 v[8:11], v24
ds_read_b128 v[12:15], v24 offset:64
s_waitcnt lgkmcnt(0)
v_mfma_f32_16x16x32_bf16 v[96:99], v[8:11], v[32:35], 0
v_mfma_f32_16x16x32_bf16 v[100:103], v[8:11], v[36:39], 0
v_mfma_f32_16x16x32_bf16 v[104:107], v[8:11], v[40:43], 0
v_mfma_f32_16x16x32_bf16 v[108:111], v[8:11], v[44:47], 0
v_mfma_f32_16x16x32_bf16 v[96:99], v[12:15], v[48:51], v[96:99]
v_mfma_f32_16x16x32_bf16 v[100:103], v[12:15], v[52:55], v[100:103]
v_mfma_f32_16x16x32_bf16 v[104:107], v[12:15], v[56:59], v[104:107]
v_mfma_f32_16x16x32_bf16 v[108:111], v[12:15], v[60:63], v[108:111]
s_nop 4
v_mov_b32 v25, v96
v_cmp_eq_u32 vcc, 1, v28
s_nop 1
v_cndmask_b32 v25, v25, v100, vcc
v_cmp_eq_u32 vcc, 2, v28
s_nop 1
v_cndmask_b32 v25, v25, v104, vcc
v_cmp_eq_u32 vcc, 3, v28
s_nop 1
v_cndmask_b32 v25, v25, v108, vcc
s_lshl_b32 s84, s3, 8
v_add_u32 v24, s84, v27
ds_write_b32 v24, v25 offset:24064
s_waitcnt lgkmcnt(0)
s_barrier
s_cmp_lg_u32 s3, 0
s_cbranch_scc1 L_end
ds_read_b32 v8, v27 offset:24064
ds_read_b32 v9, v27 offset:24320
ds_read_b32 v10, v27 offset:24576
ds_read_b32 v11, v27 offset:24832
ds_read_b32 v12, v27 offset:25088
ds_read_b32 v13, v27 offset:25344
ds_read_b32 v14, v27 offset:25600
ds_read_b32 v15, v27 offset:25856
s_waitcnt lgkmcnt(0)
v_add_f32 v8, v8, v9
v_add_f32 v8, v8, v10
v_add_f32 v8, v8, v11
v_add_f32 v8, v8, v12
v_add_f32 v8, v8, v13
v_add_f32 v8, v8, v14
v_add_f32 v8, v8, v15
v_min_u32 v8, -2, v8
buffer_store_dword v8, v27, s[52:55], s15 offen sc1
s_branch L_end
L_tG:
s_waitcnt vmcnt(0)
s_barrier
s_cmp_ge_u32 s3, 10
s_cbranch_scc1 L_end
s_mul_i32 s13, s12, 5
s_sub_u32 s13, s3, s13
s_lshl_b32 s84, s3, 8
v_add_u32 v25, s84, v27
ds_read_b32 v22, v25 offset:4096
ds_read_b32 v23, v25 offset:9216
v_add_u32 v64, 0, v25
v_add_u32 v65, 2560, v25
v_add_u32 v66, 5120, v25
v_add_u32 v67, 7680, v25
v_add_u32 v68, 10240, v25
v_add_u32 v69, 12800, v25
v_add_u32 v70, 15360, v25
v_add_u32 v71, 17920, v25
v_add_u32 v72, 20480, v25
v_add_u32 v73, 23040, v25
v_add_u32 v74, 25600, v25
v_add_u32 v75, 28160, v25
s_cmp_ge_u32 s13, 5
s_cbranch_scc1 L_tG_nopre
v_lshlrev_b32 v26, 3, v28
v_add_u32 v26, v26, v30
v_lshlrev_b32 v26, 7, v26
v_add_u32 v26, v26, v31
s_lshl_b32 s84, s13, 13
s_add_u32 s84, s84, 65536
v_add_u32 v26, s84, v26
ds_read_b64_tr_b16 v[32:33], v26 offset:0
ds_read_b64_tr_b16 v[34:35], v26 offset:512
ds_read_b64_tr_b16 v[36:37], v26 offset:32
ds_read_b64_tr_b16 v[38:39], v26 offset:544
ds_read_b64_tr_b16 v[40:41], v26 offset:64
ds_read_b64_tr_b16 v[42:43], v26 offset:576
ds_read_b64_tr_b16 v[44:45], v26 offset:96
ds_read_b64_tr_b16 v[46:47], v26 offset:608
ds_read_b64_tr_b16 v[48:49], v26 offset:4096
ds_read_b64_tr_b16 v[50:51], v26 offset:4608
ds_read_b64_tr_b16 v[52:53], v26 offset:4128
ds_read_b64_tr_b16 v[54:55], v26 offset:4640
ds_read_b64_tr_b16 v[56:57], v26 offset:4160
ds_read_b64_tr_b16 v[58:59], v26 offset:4672
ds_read_b64_tr_b16 v[60:61], v26 offset:4192
ds_read_b64_tr_b16 v[62:63], v26 offset:4704
s_lshl_b32 s84, s13, 8
v_add_u32 v24, s84, v27
ds_read_b32 v21, v24 offset:7936
ds_read_b32 v20, v24 offset:6656
v_lshlrev_b32 v18, 1, v1
v_add_u32 v18, s85, v18
v_lshlrev_b32 v19, 4, v28
v_add_u32 v19, s85, v19
v_and_b32 v17, 1, v29
v_lshlrev_b32 v17, 7, v17
v_add_u32 v17, v19, v17
s_waitcnt lgkmcnt(0)
v_cvt_pk_bf16_f32 v16, v21, v20
ds_write_b16 v18, v16
ds_write_b16_d16_hi v18, v16 offset:128
s_waitcnt lgkmcnt(0)
ds_read_b128 v[8:11], v17
ds_read_b128 v[12:15], v17 offset:64
s_waitcnt lgkmcnt(0)
v_mfma_f32_16x16x32_bf16 v[140:143], v[8:11], v[32:35], 0
v_mfma_f32_16x16x32_bf16 v[144:147], v[8:11], v[36:39], 0
v_mfma_f32_16x16x32_bf16 v[148:151], v[8:11], v[40:43], 0
v_mfma_f32_16x16x32_bf16 v[152:155], v[8:11], v[44:47], 0
v_mfma_f32_16x16x32_bf16 v[140:143], v[12:15], v[48:51], v[140:143]
v_mfma_f32_16x16x32_bf16 v[144:147], v[12:15], v[52:55], v[144:147]
v_mfma_f32_16x16x32_bf16 v[148:151], v[12:15], v[56:59], v[148:151]
v_mfma_f32_16x16x32_bf16 v[152:155], v[12:15], v[60:63], v[152:155]
s_nop 4
v_mov_b32 v16, v140
v_cmp_eq_u32 vcc, 1, v28
s_nop 1
v_cndmask_b32 v16, v16, v144, vcc
v_cmp_eq_u32 vcc, 2, v28
s_nop 1
v_cndmask_b32 v16, v16, v148, vcc
v_cmp_eq_u32 vcc, 3, v28
s_nop 1
v_cndmask_b32 v16, v16, v152, vcc
v_mov_b32 v26, v141
v_cmp_eq_u32 vcc, 1, v28
s_nop 1
v_cndmask_b32 v26, v26, v145, vcc
v_cmp_eq_u32 vcc, 2, v28
s_nop 1
v_cndmask_b32 v26, v26, v149, vcc
v_cmp_eq_u32 vcc, 3, v28
s_nop 1
v_cndmask_b32 v26, v26, v153, vcc
s_lshl_b32 s84, s13, 9
v_add_u32 v24, s84, v27
ds_write_b32 v24, v16 offset:21504
ds_write_b32 v24, v26 offset:21760
L_tG_nopre:
s_waitcnt lgkmcnt(0)
s_barrier
s_cmp_lg_u32 s13, 0
s_cbranch_scc1 L_tG_main
ds_read_b32 v8, v27 offset:21504
ds_read_b32 v100, v27 offset:21760
ds_read_b32 v9, v27 offset:22016
ds_read_b32 v101, v27 offset:22272
ds_read_b32 v10, v27 offset:22528
ds_read_b32 v102, v27 offset:22784
ds_read_b32 v11, v27 offset:23040
ds_read_b32 v103, v27 offset:23296
ds_read_b32 v12, v27 offset:23552
ds_read_b32 v104, v27 offset:23808
s_waitcnt lgkmcnt(0)
v_add_f32 v96, v8, v9
v_add_f32 v97, v100, v101
v_add_f32 v96, v96, v10
v_add_f32 v97, v97, v102
v_add_f32 v96, v96, v11
v_add_f32 v97, v97, v103
v_add_f32 v96, v96, v12
v_add_f32 v97, v97, v104
L_tG_main:
s_mov_b32 s84, 0
s_mov_b32 s90, 65536
buffer_load_dword v100, v64, s[52:55], s84 offen sc1
buffer_load_dword v101, v65, s[52:55], s84 offen sc1
buffer_load_dword v102, v66, s[52:55], s84 offen sc1
buffer_load_dword v103, v67, s[52:55], s84 offen sc1
buffer_load_dword v104, v68, s[52:55], s84 offen sc1
buffer_load_dword v105, v69, s[52:55], s84 offen sc1
buffer_load_dword v106, v70, s[52:55], s84 offen sc1
buffer_load_dword v107, v71, s[52:55], s84 offen sc1
buffer_load_dword v108, v72, s[52:55], s84 offen sc1
buffer_load_dword v109, v73, s[52:55], s84 offen sc1
buffer_load_dword v110, v74, s[52:55], s84 offen sc1
buffer_load_dword v111, v75, s[52:55], s84 offen sc1
L_poll_18:
s_waitcnt vmcnt(0)
v_max3_u32 v124, v100, v101, v102
v_max3_u32 v124, v124, v103, v104
v_max3_u32 v124, v124, v105, v106
v_max3_u32 v124, v124, v107, v108
v_max3_u32 v124, v124, v109, v110
v_max_u32 v124, v124, v111
v_cmp_eq_u32 vcc, -1, v124
s_cbranch_vccz L_polld_19
s_sub_u32 s90, s90, 1
s_cbranch_scc1 L_polld_19
s_sleep 2
v_cmp_eq_u32 vcc, -1, v100
s_nop 1
s_mov_b64 exec, vcc
buffer_load_dword v100, v64, s[52:55], s84 offen sc1
s_mov_b64 exec, -1
v_cmp_eq_u32 vcc, -1, v101
s_nop 1
s_mov_b64 exec, vcc
buffer_load_dword v101, v65, s[52:55], s84 offen sc1
s_mov_b64 exec, -1
v_cmp_eq_u32 vcc, -1, v102
s_nop 1
s_mov_b64 exec, vcc
buffer_load_dword v102, v66, s[52:55], s84 offen sc1
s_mov_b64 exec, -1
v_cmp_eq_u32 vcc, -1, v103
s_nop 1
s_mov_b64 exec, vcc
buffer_load_dword v103, v67, s[52:55], s84 offen sc1
s_mov_b64 exec, -1
v_cmp_eq_u32 vcc, -1, v104
s_nop 1
s_mov_b64 exec, vcc
buffer_load_dword v104, v68, s[52:55], s84 offen sc1
s_mov_b64 exec, -1
v_cmp_eq_u32 vcc, -1, v105
s_nop 1
s_mov_b64 exec, vcc
buffer_load_dword v105, v69, s[52:55], s84 offen sc1
s_mov_b64 exec, -1
v_cmp_eq_u32 vcc, -1, v106
s_nop 1
s_mov_b64 exec, vcc
buffer_load_dword v106, v70, s[52:55], s84 offen sc1
s_mov_b64 exec, -1
v_cmp_eq_u32 vcc, -1, v107
s_nop 1
s_mov_b64 exec, vcc
buffer_load_dword v107, v71, s[52:55], s84 offen sc1
s_mov_b64 exec, -1
v_cmp_eq_u32 vcc, -1, v108
s_nop 1
s_mov_b64 exec, vcc
buffer_load_dword v108, v72, s[52:55], s84 offen sc1
s_mov_b64 exec, -1
v_cmp_eq_u32 vcc, -1, v109
s_nop 1
s_mov_b64 exec, vcc
buffer_load_dword v109, v73, s[52:55], s84 offen sc1
s_mov_b64 exec, -1
v_cmp_eq_u32 vcc, -1, v110
s_nop 1
s_mov_b64 exec, vcc
buffer_load_dword v110, v74, s[52:55], s84 offen sc1
s_mov_b64 exec, -1
v_cmp_eq_u32 vcc, -1, v111
s_nop 1
s_mov_b64 exec, vcc
buffer_load_dword v111, v75, s[52:55], s84 offen sc1
s_mov_b64 exec, -1
s_branch L_poll_18
L_polld_19:
v_add_f32 v24, v100, v101
v_add_f32 v24, v24, v102
v_add_f32 v24, v24, v103
v_add_f32 v24, v24, v104
v_add_f32 v24, v24, v105
v_add_f32 v24, v24, v106
v_add_f32 v24, v24, v107
v_add_f32 v24, v24, v108
v_add_f32 v24, v24, v109
v_add_f32 v24, v24, v110
v_add_f32 v24, v24, v111
v_cvt_pk_bf16_f32 v24, v24, v24
v_lshlrev_b32 v24, 16, v24
v_mul_f32 v24, v22, v24
v_cvt_pk_bf16_f32 v24, v24, v24
v_lshlrev_b32 v24, 16, v24
v_add_f32 v24, v23, v24
v_cvt_pk_bf16_f32 v24, v24, v24
v_lshlrev_b32 v24, 16, v24
s_cmp_ge_u32 s13, 5
s_cbranch_scc1 L_tG_st1
v_mul_f32 v16, v24, v21
v_cvt_pk_bf16_f32 v16, v16, v16
ds_write_b16 v18, v16
s_waitcnt lgkmcnt(0)
ds_read_b128 v[8:11], v19
ds_read_b128 v[12:15], v19 offset:64
L_tG_st1:
v_mul_f32 v25, v24, v24
v_add_f32_dpp v24, v24, v24 quad_perm:[1,0,3,2] row_mask:0xf bank_mask:0xf
s_nop 0
v_add_f32_dpp v25, v25, v25 quad_perm:[1,0,3,2] row_mask:0xf bank_mask:0xf
v_add_f32_dpp v24, v24, v24 quad_perm:[2,3,0,1] row_mask:0xf bank_mask:0xf
s_nop 0
v_add_f32_dpp v25, v25, v25 quad_perm:[2,3,0,1] row_mask:0xf bank_mask:0xf
v_add_f32_dpp v24, v24, v24 row_half_mirror row_mask:0xf bank_mask:0xf
s_nop 0
v_add_f32_dpp v25, v25, v25 row_half_mirror row_mask:0xf bank_mask:0xf
v_add_f32_dpp v24, v24, v24 row_ror:8 row_mask:0xf bank_mask:0xf
s_nop 0
v_add_f32_dpp v25, v25, v25 row_ror:8 row_mask:0xf bank_mask:0xf
v_add_f32_dpp v24, v24, v24 row_bcast:15 row_mask:0xa bank_mask:0xf
s_nop 0
v_add_f32_dpp v25, v25, v25 row_bcast:15 row_mask:0xa bank_mask:0xf
v_add_f32_dpp v24, v24, v24 row_bcast:31 row_mask:0xc bank_mask:0xf
s_nop 0
v_add_f32_dpp v25, v25, v25 row_bcast:31 row_mask:0xc bank_mask:0xf
s_lshl_b32 s84, s3, 3
v_mov_b32 v17, s84
s_mov_b32 exec_lo, 0
s_mov_b32 exec_hi, 0x80000000
ds_write_b64 v17, v[24:25] offset:25344
s_mov_b64 exec, -1
s_cmp_ge_u32 s13, 5
s_cbranch_scc1 L_tG_st2
s_waitcnt lgkmcnt(1)
v_mfma_f32_16x16x32_bf16 v[140:143], v[8:11], v[32:35], 0
v_mfma_f32_16x16x32_bf16 v[144:147], v[8:11], v[36:39], 0
v_mfma_f32_16x16x32_bf16 v[148:151], v[8:11], v[40:43], 0
v_mfma_f32_16x16x32_bf16 v[152:155], v[8:11], v[44:47], 0
v_mfma_f32_16x16x32_bf16 v[140:143], v[12:15], v[48:51], v[140:143]
v_mfma_f32_16x16x32_bf16 v[144:147], v[12:15], v[52:55], v[144:147]
v_mfma_f32_16x16x32_bf16 v[148:151], v[12:15], v[56:59], v[148:151]
v_mfma_f32_16x16x32_bf16 v[152:155], v[12:15], v[60:63], v[152:155]
s_nop 4
v_mov_b32 v16, v140
v_cmp_eq_u32 vcc, 1, v28
s_nop 1
v_cndmask_b32 v16, v16, v144, vcc
v_cmp_eq_u32 vcc, 2, v28
s_nop 1
v_cndmask_b32 v16, v16, v148, vcc
v_cmp_eq_u32 vcc, 3, v28
s_nop 1
v_cndmask_b32 v16, v16, v152, vcc
s_lshl_b32 s84, s13, 8
v_add_u32 v26, s84, v27
ds_write_b32 v26, v16 offset:24064
L_tG_st2:
s_waitcnt lgkmcnt(0)
s_barrier
s_cmp_lg_u32 s13, 0
s_cbranch_scc1 L_end
v_mov_b32 v26, 0
ds_read_b128 v[100:103], v26 offset:25344
ds_read_b128 v[104:107], v26 offset:25360
ds_read_b128 v[108:111], v26 offset:25376
ds_read_b128 v[112:115], v26 offset:25392
ds_read_b128 v[116:119], v26 offset:25408
ds_read_b32 v8, v27 offset:24064
ds_read_b32 v9, v27 offset:24320
ds_read_b32 v10, v27 offset:24576
ds_read_b32 v11, v27 offset:24832
ds_read_b32 v12, v27 offset:25088
s_waitcnt lgkmcnt(5)
v_add_f32 v100, v100, v102
v_add_f32 v101, v101, v103
v_add_f32 v104, v104, v106
v_add_f32 v105, v105, v107
v_add_f32 v108, v108, v110
v_add_f32 v109, v109, v111
v_add_f32 v112, v112, v114
v_add_f32 v113, v113, v115
v_add_f32 v116, v116, v118
v_add_f32 v117, v117, v119
v_add_f32 v100, v100, v104
v_add_f32 v101, v101, v105
v_add_f32 v108, v108, v112
v_add_f32 v109, v109, v113
v_add_f32 v100, v100, v116
v_add_f32 v101, v101, v117
v_add_f32 v16, v100, v108
v_add_f32 v17, v101, v109
v_mul_f32 v16, 986500301, v16
v_mul_f32 v17, 986500301, v17
v_fma_f32 v17, -v16, v16, v17
v_max_f32 v17, 0, v17
v_cvt_pk_bf16_f32 v16, v16, v16
v_lshlrev_b32 v16, 16, v16
v_cvt_pk_bf16_f32 v17, v17, v17
v_lshlrev_b32 v17, 16, v17
v_add_f32 v17, 0x3727c5ac, v17
v_cvt_pk_bf16_f32 v17, v17, v17
v_lshlrev_b32 v17, 16, v17
v_sqrt_f32 v17, v17
s_nop 0
v_cvt_pk_bf16_f32 v17, v17, v17
v_lshlrev_b32 v17, 16, v17
s_waitcnt lgkmcnt(0)
v_add_f32 v8, v8, v9
v_add_f32 v10, v10, v11
v_add_f32 v8, v8, v12
v_add_f32 v8, v8, v10
v_fma_f32 v8, -v16, v96, v8
v_rcp_f32 v10, v17
s_nop 0
v_mul_f32 v9, v8, v10
v_fma_f32 v11, -v9, v17, v8
v_fma_f32 v9, v11, v10, v9
v_add_f32 v8, v9, v97
v_min_u32 v8, -2, v8
buffer_store_dword v8, v27, s[52:55], s15 offen sc1
s_branch L_end
L_tD:
s_waitcnt vmcnt(0)
s_barrier
v_lshlrev_b32 v26, 3, v28
v_add_u32 v26, v26, v30
v_lshlrev_b32 v26, 6, v26
v_add_u32 v26, v26, v31
s_lshl_b32 s84, s3, 13
s_add_u32 s84, s84, 65536
v_add_u32 v26, s84, v26
ds_read_b64_tr_b16 v[32:33], v26 offset:0
ds_read_b64_tr_b16 v[34:35], v26 offset:256
ds_read_b64_tr_b16 v[36:37], v26 offset:32
ds_read_b64_tr_b16 v[38:39], v26 offset:288
ds_read_b64_tr_b16 v[40:41], v26 offset:2048
ds_read_b64_tr_b16 v[42:43], v26 offset:2304
ds_read_b64_tr_b16 v[44:45], v26 offset:2080
ds_read_b64_tr_b16 v[46:47], v26 offset:2336
ds_read_b64_tr_b16 v[48:49], v26 offset:4096
ds_read_b64_tr_b16 v[50:51], v26 offset:4352
ds_read_b64_tr_b16 v[52:53], v26 offset:4128
ds_read_b64_tr_b16 v[54:55], v26 offset:4384
ds_read_b64_tr_b16 v[56:57], v26 offset:6144
ds_read_b64_tr_b16 v[58:59], v26 offset:6400
ds_read_b64_tr_b16 v[60:61], v26 offset:6176
ds_read_b64_tr_b16 v[62:63], v26 offset:6432
s_cmp_lg_u32 s3, 0
s_cbranch_scc1 L_tD_nox1
v_and_b32 v25, 31, v1
v_lshlrev_b32 v25, 2, v25
s_lshl_b32 s84, s10, 7
v_add_u32 v24, s84, v25
ds_read_b32 v100, v25 offset:4096
ds_read_b32 v101, v24 offset:9216
ds_read_b32 v102, v25 offset:6656
s_lshl_b32 s84, s10, 7
s_add_u32 s84, s84, 0
v_add_u32 v64, 0, v25
v_add_u32 v65, 2560, v25
v_add_u32 v66, 5120, v25
v_add_u32 v67, 7680, v25
v_add_u32 v68, 10240, v25
v_add_u32 v69, 12800, v25
v_add_u32 v70, 15360, v25
v_add_u32 v71, 17920, v25
v_add_u32 v72, 20480, v25
v_add_u32 v73, 23040, v25
v_add_u32 v74, 25600, v25
v_add_u32 v75, 28160, v25
v_mul_u32_u24 v104, 2560, v1
s_mov_b32 s90, 65536
buffer_load_dword v8, v64, s[52:55], s84 offen sc1
buffer_load_dword v9, v65, s[52:55], s84 offen sc1
buffer_load_dword v10, v66, s[52:55], s84 offen sc1
buffer_load_dword v11, v67, s[52:55], s84 offen sc1
buffer_load_dword v12, v68, s[52:55], s84 offen sc1
buffer_load_dword v13, v69, s[52:55], s84 offen sc1
buffer_load_dword v14, v70, s[52:55], s84 offen sc1
buffer_load_dword v15, v71, s[52:55], s84 offen sc1
buffer_load_dword v16, v72, s[52:55], s84 offen sc1
buffer_load_dword v17, v73, s[52:55], s84 offen sc1
buffer_load_dword v18, v74, s[52:55], s84 offen sc1
buffer_load_dword v19, v75, s[52:55], s84 offen sc1
L_poll_20:
s_waitcnt vmcnt(0)
v_max3_u32 v124, v8, v9, v10
v_max3_u32 v124, v124, v11, v12
v_max3_u32 v124, v124, v13, v14
v_max3_u32 v124, v124, v15, v16
v_max3_u32 v124, v124, v17, v18
v_max_u32 v124, v124, v19
v_cmp_eq_u32 vcc, -1, v124
s_cbranch_vccz L_polld_21
s_sub_u32 s90, s90, 1
s_cbranch_scc1 L_polld_21
s_sleep 2
v_cmp_eq_u32 vcc, -1, v8
s_nop 1
s_mov_b64 exec, vcc
buffer_load_dword v8, v64, s[52:55], s84 offen sc1
s_mov_b64 exec, -1
v_cmp_eq_u32 vcc, -1, v9
s_nop 1
s_mov_b64 exec, vcc
buffer_load_dword v9, v65, s[52:55], s84 offen sc1
s_mov_b64 exec, -1
v_cmp_eq_u32 vcc, -1, v10
s_nop 1
s_mov_b64 exec, vcc
buffer_load_dword v10, v66, s[52:55], s84 offen sc1
s_mov_b64 exec, -1
v_cmp_eq_u32 vcc, -1, v11
s_nop 1
s_mov_b64 exec, vcc
buffer_load_dword v11, v67, s[52:55], s84 offen sc1
s_mov_b64 exec, -1
v_cmp_eq_u32 vcc, -1, v12
s_nop 1
s_mov_b64 exec, vcc
buffer_load_dword v12, v68, s[52:55], s84 offen sc1
s_mov_b64 exec, -1
v_cmp_eq_u32 vcc, -1, v13
s_nop 1
s_mov_b64 exec, vcc
buffer_load_dword v13, v69, s[52:55], s84 offen sc1
s_mov_b64 exec, -1
v_cmp_eq_u32 vcc, -1, v14
s_nop 1
s_mov_b64 exec, vcc
buffer_load_dword v14, v70, s[52:55], s84 offen sc1
s_mov_b64 exec, -1
v_cmp_eq_u32 vcc, -1, v15
s_nop 1
s_mov_b64 exec, vcc
buffer_load_dword v15, v71, s[52:55], s84 offen sc1
s_mov_b64 exec, -1
v_cmp_eq_u32 vcc, -1, v16
s_nop 1
s_mov_b64 exec, vcc
buffer_load_dword v16, v72, s[52:55], s84 offen sc1
s_mov_b64 exec, -1
v_cmp_eq_u32 vcc, -1, v17
s_nop 1
s_mov_b64 exec, vcc
buffer_load_dword v17, v73, s[52:55], s84 offen sc1
s_mov_b64 exec, -1
v_cmp_eq_u32 vcc, -1, v18
s_nop 1
s_mov_b64 exec, vcc
buffer_load_dword v18, v74, s[52:55], s84 offen sc1
s_mov_b64 exec, -1
v_cmp_eq_u32 vcc, -1, v19
s_nop 1
s_mov_b64 exec, vcc
buffer_load_dword v19, v75, s[52:55], s84 offen sc1
s_mov_b64 exec, -1
s_branch L_poll_20
L_polld_21:
v_add_f32 v24, v8, v9
v_add_f32 v24, v24, v10
v_add_f32 v24, v24, v11
v_add_f32 v24, v24, v12
v_add_f32 v24, v24, v13
v_add_f32 v24, v24, v14
v_add_f32 v24, v24, v15
v_add_f32 v24, v24, v16
v_add_f32 v24, v24, v17
v_add_f32 v24, v24, v18
v_add_f32 v24, v24, v19
v_cvt_pk_bf16_f32 v24, v24, v24
v_lshlrev_b32 v24, 16, v24
s_waitcnt lgkmcnt(0)
v_mul_f32 v24, v100, v24
v_cvt_pk_bf16_f32 v24, v24, v24
v_lshlrev_b32 v24, 16, v24
v_add_f32 v101, v101, v24
v_cvt_pk_bf16_f32 v101, v101, v101
v_lshlrev_b32 v101, 16, v101
L_tD_nox1:
v_lshlrev_b32 v25, 3, v1
s_lshl_b32 s84, s3, 9
v_add_u32 v25, s84, v25
v_add_u32 v64, 0, v25
v_add_u32 v65, 6144, v25
v_add_u32 v66, 12288, v25
v_add_u32 v67, 18432, v25
s_mov_b32 s84, 30720
v_lshrrev_b32 v104, 1, v1
v_mul_u32_u24 v104, 6144, v104
v_and_b32 v105, 1, v1
v_lshlrev_b32 v105, 8, v105
v_add_u32 v104, v104, v105
s_lshl_b32 s88, s3, 9
v_add_u32 v104, s88, v104
s_mov_b32 s90, 65536
buffer_load_dwordx2 v[8:9], v64, s[52:55], s84 offen sc1
buffer_load_dwordx2 v[10:11], v65, s[52:55], s84 offen sc1
buffer_load_dwordx2 v[12:13], v66, s[52:55], s84 offen sc1
buffer_load_dwordx2 v[14:15], v67, s[52:55], s84 offen sc1
L_poll_22:
s_waitcnt vmcnt(0)
v_max_u32 v124, v8, v9
v_max_u32 v125, v10, v11
v_max_u32 v126, v12, v13
v_max_u32 v127, v14, v15
v_max3_u32 v128, v124, v125, v126
v_max_u32 v128, v128, v127
v_cmp_eq_u32 vcc, -1, v128
s_cbranch_vccz L_polld_23
s_sub_u32 s90, s90, 1
s_cbranch_scc1 L_polld_23
s_sleep 2
v_cmp_eq_u32 vcc, -1, v124
s_nop 1
s_mov_b64 exec, vcc
buffer_load_dwordx2 v[8:9], v64, s[52:55], s84 offen sc1
s_mov_b64 exec, -1
v_cmp_eq_u32 vcc, -1, v125
s_nop 1
s_mov_b64 exec, vcc
buffer_load_dwordx2 v[10:11], v65, s[52:55], s84 offen sc1
s_mov_b64 exec, -1
v_cmp_eq_u32 vcc, -1, v126
s_nop 1
s_mov_b64 exec, vcc
buffer_load_dwordx2 v[12:13], v66, s[52:55], s84 offen sc1
s_mov_b64 exec, -1
v_cmp_eq_u32 vcc, -1, v127
s_nop 1
s_mov_b64 exec, vcc
buffer_load_dwordx2 v[14:15], v67, s[52:55], s84 offen sc1
s_mov_b64 exec, -1
s_branch L_poll_22
L_polld_23:
v_add_f32 v16, v8, v12
v_add_f32 v17, v9, v13
v_add_f32 v18, v10, v14
v_add_f32 v19, v11, v15
v_cvt_pk_bf16_f32 v16, v16, v17
v_cvt_pk_bf16_f32 v18, v18, v19
v_lshlrev_b32 v20, 16, v16
v_and_b32 v21, 0xffff0000, v16
v_lshlrev_b32 v22, 16, v18
v_and_b32 v23, 0xffff0000, v18
v_mul_f32 v20, v20, v22
v_mul_f32 v21, v21, v23
v_cvt_pk_bf16_f32 v20, v20, v21
v_add_u32 v24, s85, v27
ds_write_b32 v24, v20
v_lshlrev_b32 v24, 4, v28
v_add_u32 v24, s85, v24
s_waitcnt lgkmcnt(0)
ds_read_b128 v[144:147], v24 offset:0
ds_read_b128 v[148:151], v24 offset:64
ds_read_b128 v[152:155], v24 offset:128
ds_read_b128 v[156:159], v24 offset:192
s_waitcnt lgkmcnt(0)
v_mfma_f32_16x16x32_bf16 v[88:91], v[144:147], v[32:35], 0
v_mfma_f32_16x16x32_bf16 v[92:95], v[144:147], v[36:39], 0
v_mfma_f32_16x16x32_bf16 v[88:91], v[148:151], v[40:43], v[88:91]
v_mfma_f32_16x16x32_bf16 v[92:95], v[148:151], v[44:47], v[92:95]
v_mfma_f32_16x16x32_bf16 v[88:91], v[152:155], v[48:51], v[88:91]
v_mfma_f32_16x16x32_bf16 v[92:95], v[152:155], v[52:55], v[92:95]
v_mfma_f32_16x16x32_bf16 v[88:91], v[156:159], v[56:59], v[88:91]
v_mfma_f32_16x16x32_bf16 v[92:95], v[156:159], v[60:63], v[92:95]
s_nop 6
v_mov_b32 v24, v88
v_cmp_eq_u32 vcc, 1, v28
s_nop 1
v_cndmask_b32 v24, v24, v92, vcc
s_lshl_b32 s84, s3, 8
v_add_u32 v25, s84, v27
s_mov_b32 exec_hi, 0
ds_write_b32 v25, v24 offset:24064
s_mov_b64 exec, -1
s_waitcnt lgkmcnt(0)
s_barrier
s_cmp_lg_u32 s3, 0
s_cbranch_scc1 L_end
ds_read_b32 v144, v27 offset:24064
ds_read_b32 v145, v27 offset:24320
ds_read_b32 v146, v27 offset:24576
ds_read_b32 v147, v27 offset:24832
ds_read_b32 v148, v27 offset:25088
ds_read_b32 v149, v27 offset:25344
ds_read_b32 v150, v27 offset:25600
ds_read_b32 v151, v27 offset:25856
ds_read_b32 v152, v27 offset:26112
ds_read_b32 v153, v27 offset:26368
ds_read_b32 v154, v27 offset:26624
ds_read_b32 v155, v27 offset:26880
s_waitcnt lgkmcnt(0)
v_add_f32 v144, v144, v145
v_add_f32 v144, v144, v146
v_add_f32 v144, v144, v147
v_add_f32 v144, v144, v148
v_add_f32 v144, v144, v149
v_add_f32 v144, v144, v150
v_add_f32 v144, v144, v151
v_add_f32 v144, v144, v152
v_add_f32 v144, v144, v153
v_add_f32 v144, v144, v154
v_add_f32 v144, v144, v155
v_cvt_pk_bf16_f32 v144, v144, v144
v_lshlrev_b32 v144, 16, v144
v_mul_f32 v144, v102, v144
v_cvt_pk_bf16_f32 v144, v144, v144
v_lshlrev_b32 v144, 16, v144
v_add_f32 v144, v101, v144
v_cvt_pk_bf16_f32 v144, v144, v144
v_lshlrev_b32 v145, 1, v1
s_lshl_b32 s84, s10, 6
s_mov_b32 exec_hi, 0
buffer_store_short v144, v145, s[80:83], s84 offen
s_cmp_lg_u32 s10, 0
s_cbranch_scc1 L_nogen
v_mov_b32 v146, s42
v_mov_b32 v147, 901120
s_mov_b64 exec, 1
buffer_store_dword v146, v147, s[52:55], 0 offen sc1
L_nogen:
s_mov_b64 exec, -1
L_end:
s_endpgm

.section .rodata,"a"
.p2align 6
.amdhsa_kernel adaLN_cond__sliding_block_cached__glu_gated_bilinear__decode_kernel
  .amdhsa_next_free_vgpr 168
  .amdhsa_next_free_sgpr 102
  .amdhsa_accum_offset 168
  .amdhsa_group_segment_fixed_size 0
  .amdhsa_kernarg_size 112
  .amdhsa_user_sgpr_count 2
  .amdhsa_user_sgpr_kernarg_segment_ptr 1
  .amdhsa_system_sgpr_workgroup_id_x 1
.end_amdhsa_kernel
```
